```python
import torch

def _softmax(x, axis=-1):
    return torch.softmax(x, dim=axis)
def _gelu(x):
    return torch.nn.functional.gelu(x, approximate="tanh")
def _silu(x):
    return torch.nn.functional.silu(x)
def _sigmoid(x):
    return torch.sigmoid(x)
def _layernorm(x, axis=-1, eps=1e-5):
    m = x.mean(dim=axis, keepdim=True)
    v = x.var(dim=axis, keepdim=True, unbiased=False)
    return (x - m) / torch.sqrt(v + eps)
def _scatter_add(tgt, idx, src, axis=0):
    return tgt.clone().index_add_(axis, idx, src)
def _segment_sum(src, seg, n):
    out = torch.zeros((n,) + src.shape[1:], dtype=src.dtype)
    return out.index_add_(0, seg, src)
def _pad(x, pw):
    flat = tuple(v for pair in reversed(pw) for v in pair)
    return torch.nn.functional.pad(x, flat)

kernel_name = 'gated_mix__sliding_block_cached__gqa_block_cached__decode'

def setup_inputs():

    _w = (lambda a: (lambda t: t.to(torch.bfloat16) if t.is_floating_point() else t)(torch.as_tensor(a)))
    def _A_setup():
        B, Sq, D = 2, 1, 1024
        Hq, Hkv, Sk, Dh = 32, 4, 32768, 128
        assert Hq % Hkv == 0, (Hq, Hkv)
        return {
            "x": _w((lambda *s: torch.randn(*s, dtype=torch.bfloat16) * 0.05)(B, Sq, D)),
            "k_cache": _w((lambda *s: torch.randn(*s, dtype=torch.bfloat16) * 6.4)(B, Hkv, Sk, Dh)),
            "v_cache": _w((lambda *s: torch.randn(*s, dtype=torch.bfloat16) * 0.05)(B, Hkv, Sk, Dh)),
            "wq": _w((lambda *s: torch.randn(*s, dtype=torch.bfloat16) * 6.4)(D, Hq * Dh) * (D ** -0.5)),
            "wo": _w((lambda *s: torch.randn(*s, dtype=torch.bfloat16) * 0.05)(Hq * Dh, D) * ((Hq * Dh) ** -0.5)),
        }
    _A_in = _A_setup()

    def _B_setup():
        B, Sq, D = 2, 1, 1024
        Hq, Hkv, Sk, Dh = 32, 4, 32768, 128
        assert Hq % Hkv == 0, (Hq, Hkv)
        return {
            "x": _w((lambda *s: torch.randn(*s, dtype=torch.bfloat16) * 0.05)(B, Sq, D)),
            "k_cache": _w((lambda *s: torch.randn(*s, dtype=torch.bfloat16) * 6.4)(B, Hkv, Sk, Dh)),
            "v_cache": _w((lambda *s: torch.randn(*s, dtype=torch.bfloat16) * 0.05)(B, Hkv, Sk, Dh)),
            "wq": _w((lambda *s: torch.randn(*s, dtype=torch.bfloat16) * 6.4)(D, Hq * Dh) * (D ** -0.5)),
            "wo": _w((lambda *s: torch.randn(*s, dtype=torch.bfloat16) * 0.05)(Hq * Dh, D) * ((Hq * Dh) ** -0.5)),
        }
    _B_in = _B_setup()

    return {
        "A_x": _A_in["x"],
        "A_k_cache": _A_in["k_cache"],
        "A_v_cache": _A_in["v_cache"],
        "A_wq": _A_in["wq"],
        "A_wo": _A_in["wo"],
        "B_x": _B_in["x"],
        "B_k_cache": _B_in["k_cache"],
        "B_v_cache": _B_in["v_cache"],
        "B_wq": _B_in["wq"],
        "B_wo": _B_in["wo"],
        "gate_w": _w((lambda *s: torch.randn(*s, dtype=torch.bfloat16) * 0.05)(1024) * 16.0),
    }

def reference(A_x, A_k_cache, A_v_cache, A_wq, A_wo, B_x, B_k_cache, B_v_cache, B_wq, B_wo, gate_w):
    def _A_ref(x, k_cache, v_cache, wq, wo):
        B, Sq, D = x.shape
        Hq, Dh = 32, 128
        Hkv, Sk = k_cache.shape[1], k_cache.shape[2]
        W = min(4096, max(256, Sk // 4))
        rep = Hq // Hkv
        q = (lambda x, *d: x.permute(*d))((x @ wq).reshape(B, Sq, Hq, Dh), 0, 2, 1, 3)
        k = (lambda x, n, axis: torch.repeat_interleave(x, n, dim=axis))(k_cache[:, :, Sk - W:, :], rep, axis=1)
        v = (lambda x, n, axis: torch.repeat_interleave(x, n, dim=axis))(v_cache[:, :, Sk - W:, :], rep, axis=1)
        scores = torch.einsum("bhqd,bhkd->bhqk", q, k) * (Dh ** -0.5)
        p = _softmax(scores, axis=-1)
        o = torch.einsum("bhqk,bhkd->bhqd", p, v)
        return (lambda x, *d: x.permute(*d))(o, 0, 2, 1, 3).reshape(B, Sq, Hq * Dh) @ wo

    def _B_ref(x, k_cache, v_cache, wq, wo):
        B, Sq, D = x.shape
        Hq, Dh = 32, 128
        Hkv = k_cache.shape[1]
        rep = Hq // Hkv
        q = (lambda x, *d: x.permute(*d))((x @ wq).reshape(B, Sq, Hq, Dh), 0, 2, 1, 3)
        k = (lambda x, n, axis: torch.repeat_interleave(x, n, dim=axis))(k_cache, rep, axis=1)
        v = (lambda x, n, axis: torch.repeat_interleave(x, n, dim=axis))(v_cache, rep, axis=1)
        scores = torch.einsum("bhqd,bhkd->bhqk", q, k) * (Dh ** -0.5)
        p = _softmax(scores, axis=-1)
        o = torch.einsum("bhqk,bhkd->bhqd", p, v)
        return (lambda x, *d: x.permute(*d))(o, 0, 2, 1, 3).reshape(B, Sq, Hq * Dh) @ wo

    x = A_x
    g = _sigmoid((x * gate_w).sum(-1, keepdims=True))
    a = _A_ref(x, A_k_cache, A_v_cache, A_wq, A_wo)
    b = _B_ref(x, B_k_cache, B_v_cache, B_wq, B_wo)
    return g * a + (1 - g) * b
```

```asm
; @launch grid=(256,1,1) block=(256,1,1) lds=77824
.amdgcn_target "amdgcn-amd-amdhsa--gfx950"
.text
.globl gated_mix__sliding_block_cached__gqa_block_cached__decode_kernel
.p2align 8
.type gated_mix__sliding_block_cached__gqa_block_cached__decode_kernel,@function
gated_mix__sliding_block_cached__gqa_block_cached__decode_kernel:
    s_cmp_ge_u32 s2, 256
    s_cbranch_scc1 L_end
    s_load_dwordx16 s[8:23], s[0:1], 0
    s_load_dwordx8 s[24:31], s[0:1], 64
    s_load_dwordx2 s[34:35], s[0:1], 104
    v_lshrrev_b32 v7, 6, v0
    v_and_b32 v0, 63, v0
    v_readfirstlane_b32 s3, v7
    v_lshrrev_b32 v7, 3, v0
    v_and_b32 v8, 7, v0
    v_lshlrev_b32 v85, 14, v7
    v_lshl_add_u32 v85, v8, 4, v85
    v_lshlrev_b32 v1, 4, v0
    v_mov_b32 v6, 0
    v_bfe_u32 v9, v0, 4, 1
    v_lshlrev_b32 v9, 11, v9
    v_and_b32 v10, 15, v0
    v_lshl_add_u32 v9, v10, 4, v9
    s_lshr_b32 s80, s2, 7
    s_bfe_u32 s81, s2, 0x20005
    s_and_b32 s82, s2, 31
    s_and_b32 s83, s82, 15
    s_lshl_b32 s83, s83, 6
    s_lshl_b32 s84, s81, 10
    s_add_u32 s32, s83, s84
    s_lshr_b32 s83, s82, 4
    s_lshl_b32 s83, s83, 2
    s_add_u32 s83, s83, s3
    s_lshl_b32 s87, s83, 20
    s_lshl_b32 s84, s32, 1
    s_add_u32 s87, s87, s84
    s_lshl_b32 s83, s83, 8
    s_mov_b32 s70, 4096
    s_mov_b32 s71, 0x20000
    s_mov_b32 s54, 0x800000
    s_mov_b32 s55, 0x20000
    s_mov_b32 s66, 302000128
    s_mov_b32 s67, 0x20000
    s_lshr_b32 s90, s2, 5
    s_lshl_b32 s90, s90, 2
    s_add_u32 s90, s90, s3
    s_lshl_b32 s90, s90, 8
    s_add_u32 s90, s90, 16384
    s_cmp_eq_u32 s80, 0
    s_waitcnt lgkmcnt(0)
    s_cselect_b32 s52, s14, s24
    s_cselect_b32 s53, s15, s25
    s_mov_b32 s68, s8
    s_mov_b32 s69, s9
    s_mov_b32 s64, s34
    s_mov_b32 s65, s35
    buffer_load_dwordx4 v[68:71], v9, s[68:71], s83 offen
    buffer_load_dword v87, v6, s[64:67], 0 offen sc1
    s_cmp_lg_u32 s82, 0
    s_cbranch_scc1 L_noinit
    s_mov_b64 exec, 1
    buffer_store_dword v6, v6, s[64:67], s90 offen sc1
    s_sub_u32 s84, s90, 16384
    s_lshl_b32 s84, s84, 2
    s_add_u32 s84, s84, 393216
    s_mov_b64 exec, 15
    v_lshlrev_b32 v7, 8, v0
    buffer_store_dword v6, v7, s[64:67], s84 offen sc1
    s_add_u32 s84, s84, 32768
    buffer_store_dword v6, v7, s[64:67], s84 offen sc1
    s_mov_b64 exec, -1
L_noinit:
    buffer_load_dwordx4 v[192:195], v85, s[52:55], s87 offen nt
    s_add_u32 s87, s87, 8192
    buffer_load_dwordx4 v[196:199], v85, s[52:55], s87 offen nt
    s_add_u32 s87, s87, 122880
    buffer_load_dwordx4 v[200:203], v85, s[52:55], s87 offen nt
    s_add_u32 s87, s87, 8192
    buffer_load_dwordx4 v[204:207], v85, s[52:55], s87 offen nt
    s_add_u32 s87, s87, 122880
    buffer_load_dwordx4 v[208:211], v85, s[52:55], s87 offen nt
    s_add_u32 s87, s87, 8192
    buffer_load_dwordx4 v[212:215], v85, s[52:55], s87 offen nt
    s_add_u32 s87, s87, 122880
    buffer_load_dwordx4 v[216:219], v85, s[52:55], s87 offen nt
    s_add_u32 s87, s87, 8192
    buffer_load_dwordx4 v[220:223], v85, s[52:55], s87 offen nt
    s_add_u32 s87, s87, 122880
    buffer_load_dwordx4 v[224:227], v85, s[52:55], s87 offen nt
    s_add_u32 s87, s87, 8192
    buffer_load_dwordx4 v[228:231], v85, s[52:55], s87 offen nt
    s_add_u32 s87, s87, 122880
    buffer_load_dwordx4 v[232:235], v85, s[52:55], s87 offen nt
    s_add_u32 s87, s87, 8192
    buffer_load_dwordx4 v[236:239], v85, s[52:55], s87 offen nt
    s_add_u32 s87, s87, 122880
    buffer_load_dwordx4 v[240:243], v85, s[52:55], s87 offen nt
    s_add_u32 s87, s87, 8192
    buffer_load_dwordx4 v[244:247], v85, s[52:55], s87 offen nt
    s_add_u32 s87, s87, 122880
    buffer_load_dwordx4 v[248:251], v85, s[52:55], s87 offen nt
    s_add_u32 s87, s87, 8192
    buffer_load_dwordx4 v[252:255], v85, s[52:55], s87 offen nt
    s_mov_b32 s36, s10
    s_mov_b32 s37, s11
    s_mov_b32 s38, 67108864
    s_mov_b32 s39, 0x20000
    s_mov_b32 s40, s12
    s_mov_b32 s41, s13
    s_mov_b32 s42, 67108864
    s_mov_b32 s43, 0x20000
    s_mov_b32 s44, s20
    s_mov_b32 s45, s21
    s_mov_b32 s46, 67108864
    s_mov_b32 s47, 0x20000
    s_mov_b32 s48, s22
    s_mov_b32 s49, s23
    s_mov_b32 s50, 67108864
    s_mov_b32 s51, 0x20000
    s_mov_b32 s72, s28
    s_mov_b32 s73, s29
    s_mov_b32 s74, 2048
    s_mov_b32 s75, 0x20000
    s_mov_b32 s76, s30
    s_mov_b32 s77, s31
    s_mov_b32 s78, 4096
    s_mov_b32 s79, 0x20000
    s_cmp_lt_u32 s3, 2
    s_cselect_b32 s56, s16, s26
    s_cselect_b32 s57, s17, s27
    s_mov_b32 s58, 0x800000
    s_mov_b32 s59, 0x20000
    v_mov_b32 v3, 5632
    v_mov_b32 v4, 1
    v_mov_b32 v20, 0
    v_mov_b32 v21, 0
    v_mov_b32 v22, 0
    v_mov_b32 v23, 0
    ds_write_b128 v3, v[20:23]
    ds_write_b128 v3, v[20:23] offset:16
    ds_write_b128 v3, v[20:23] offset:32
    s_waitcnt lgkmcnt(0)
    s_barrier
    s_lshr_b32 s96, s3, 1
    s_or_b32 s96, s96, s80
    v_lshrrev_b32 v9, 4, v0
    v_and_b32 v10, 15, v0
    v_and_b32 v8, 3, v0
    v_bfe_u32 v7, v0, 2, 2
    v_lshl_add_u32 v7, v8, 2, v7
    s_mul_i32 s83, s3, 8704
    s_add_u32 s83, s83, 43008
    v_mul_u32_u24 v84, 272, v7
    v_lshl_add_u32 v84, v9, 4, v84
    v_add_u32 v84, s83, v84
    v_mul_u32_u24 v83, 272, v9
    v_lshl_add_u32 v83, v10, 4, v83
    v_add_u32 v83, s83, v83
    v_lshlrev_b32 v2, 12, v9
    v_lshl_add_u32 v2, v10, 4, v2
    s_lshr_b32 s83, s2, 5
    s_xor_b32 s85, s2, s83
    s_lshl_b32 s85, s85, 18
    s_lshl_b32 s83, s3, 13
    s_add_u32 s85, s85, s83
    s_lshr_b32 s86, s2, 5
    s_lshl_b32 s86, s86, 23
    s_lshl_b32 s84, s82, 15
    s_add_u32 s86, s86, s84
    s_add_u32 s86, s86, s83
    s_add_u32 s86, s86, 7340032
    s_mov_b32 s91, 0x05040100
    s_mov_b32 s92, 0x07060302
    s_mov_b32 s93, 0x3fb8aa3b
    s_mov_b32 s4, 0x3db504f3
    s_mov_b32 s5, 0x3db504f3
    s_mov_b32 s95, 0xfff
    s_mov_b32 s98, 0xffff0000
    s_lshl_b32 s83, s80, 4
    s_and_b32 s99, s82, 15
    s_add_u32 s99, s99, s83
    s_lshl_b32 s84, s81, 5
    s_add_u32 s99, s99, s84
    s_lshr_b32 s83, s82, 4
    s_lshl_b32 s83, s83, 1
    s_and_b32 s84, s3, 1
    s_add_u32 s83, s83, s84
    s_lshl_b32 s88, s99, 16
    s_lshl_b32 s84, s83, 9
    s_add_u32 s88, s88, s84
    s_lshl_b32 s94, s83, 18
    s_add_u32 s94, s94, 4194304
    s_lshl_b32 s84, s99, 6
    s_add_u32 s94, s94, s84
    s_lshr_b32 s84, s3, 1
    s_lshl_b32 s84, s84, 13
    s_add_u32 s94, s94, s84
    s_lshr_b32 s83, s2, 5
    s_lshl_b32 s97, s83, 17
    s_add_u32 s97, s97, 2097152
    s_lshl_b32 s84, s82, 7
    s_add_u32 s97, s97, s84
    s_lshl_b32 s60, s83, 11
    s_and_b32 s84, s82, 7
    s_lshl_b32 s84, s84, 5
    s_add_u32 s60, s60, s84
    s_lshr_b32 s84, s82, 3
    s_lshl_b32 s84, s84, 3
    s_add_u32 s60, s60, s84
    s_add_u32 s60, s60, 65536
    s_lshl_b32 s61, s2, 1
    s_and_b32 s84, s3, 1
    s_add_u32 s61, s61, s84
    s_lshl_b32 s61, s61, 7
    s_add_u32 s61, s61, 262144
    s_lshl_b32 s62, s3, 19
    s_lshl_b32 s84, s99, 12
    s_add_u32 s62, s62, s84
    s_add_u32 s62, s62, 2097152
    s_and_b32 s83, s3, 1
    s_lshl_b32 s63, s83, 13
    s_lshr_b32 s84, s99, 2
    s_lshl_b32 s84, s84, 8
    s_add_u32 s63, s63, s84
    s_add_u32 s63, s63, 65536
    s_lshl_b32 s34, s83, 15
    s_lshl_b32 s84, s81, 13
    s_add_u32 s34, s34, s84
    s_bfe_u32 s84, s99, 0x20002
    s_lshl_b32 s84, s84, 3
    s_add_u32 s34, s34, s84
    s_bfe_u32 s84, s99, 0x10004
    s_lshl_b32 s84, s84, 7
    s_add_u32 s34, s34, s84
    s_add_u32 s34, s34, 262144
    s_cmp_lt_u32 s3, 2
    s_cselect_b32 s63, s63, s34
    s_lshr_b32 s83, s3, 1
    s_lshl_b32 s33, s83, 16
    s_lshl_b32 s83, s80, 14
    s_add_u32 s33, s33, s83
    s_lshl_b32 s83, s81, 12
    s_add_u32 s33, s33, s83
    s_and_b32 s83, s3, 1
    s_lshl_b32 s83, s83, 11
    s_add_u32 s33, s33, s83
    s_add_u32 s33, s33, 131072
    s_lshl_b32 s32, s32, 2
    s_lshl_b32 s83, s80, 16
    s_add_u32 s32, s32, s83
    s_lshr_b32 s83, s82, 4
    s_lshl_b32 s83, s83, 15
    s_add_u32 s32, s32, s83
    s_add_u32 s32, s32, 131072
    s_lshl_b32 s83, s3, 9
    v_add_u32 v7, s83, v1
    v_lshrrev_b32 v8, 3, v0
    v_lshlrev_b32 v8, 2, v8
    v_add_u32 v8, s83, v8
    v_mov_b32 v96, 0
    v_mov_b32 v97, 0
    v_mov_b32 v98, 0
    v_mov_b32 v99, 0
    v_mov_b32 v100, 0
    v_mov_b32 v101, 0
    v_mov_b32 v102, 0
    v_mov_b32 v103, 0
    v_mov_b32 v104, 0
    v_mov_b32 v105, 0
    v_mov_b32 v106, 0
    v_mov_b32 v107, 0
    v_mov_b32 v108, 0
    v_mov_b32 v109, 0
    v_mov_b32 v110, 0
    v_mov_b32 v111, 0
    s_waitcnt vmcnt(16)
    s_mov_b32 exec_hi, 0
    ds_write_b128 v7, v[68:71] offset:5888
    s_mov_b64 exec, -1
    v_add_u32 v8, 5888, v8
    ds_read2_b32 v[52:53], v8 offset0:0 offset1:8
    ds_read2_b32 v[54:55], v8 offset0:16 offset1:24
    ds_read2_b32 v[56:57], v8 offset0:32 offset1:40
    ds_read2_b32 v[58:59], v8 offset0:48 offset1:56
    ds_read2_b32 v[60:61], v8 offset0:64 offset1:72
    ds_read2_b32 v[62:63], v8 offset0:80 offset1:88
    ds_read2_b32 v[64:65], v8 offset0:96 offset1:104
    ds_read2_b32 v[66:67], v8 offset0:112 offset1:120
    v_readfirstlane_b32 s101, v87
    s_nop 0
    s_add_u32 s101, s101, 1
    s_and_b32 s89, s101, 0xfff
    v_mov_b32 v5, s89
    v_lshrrev_b32 v7, 5, v0
    v_lshlrev_b32 v7, 8, v7
    v_and_b32 v8, 7, v0
    v_lshl_add_u32 v7, v8, 5, v7
    v_and_b32 v9, 16, v0
    v_add_u32 v7, v7, v9
    v_add_u32 v7, s83, v7
    v_lshlrev_b32 v8, 10, v9
    v_and_b32 v9, 15, v0
    v_lshl_add_u32 v8, v9, 4, v8
    s_mov_b32 s6, 0x00ff00ff
    s_mov_b32 s7, 0x00ff00ff
    s_waitcnt lgkmcnt(0)
    s_waitcnt vmcnt(14)
    v_perm_b32 v20, v196, v192, s91
    v_perm_b32 v21, v196, v192, s92
    v_perm_b32 v22, v197, v193, s91
    v_perm_b32 v23, v197, v193, s92
    v_perm_b32 v24, v198, v194, s91
    v_perm_b32 v25, v198, v194, s92
    v_perm_b32 v26, v199, v195, s91
    v_perm_b32 v27, v199, v195, s92
    v_dot2c_f32_bf16 v96, v20, v52
    v_dot2c_f32_bf16 v97, v21, v52
    v_dot2c_f32_bf16 v104, v20, v60
    v_dot2c_f32_bf16 v105, v21, v60
    v_dot2c_f32_bf16 v98, v22, v52
    v_dot2c_f32_bf16 v99, v23, v52
    v_dot2c_f32_bf16 v106, v22, v60
    v_dot2c_f32_bf16 v107, v23, v60
    v_dot2c_f32_bf16 v100, v24, v52
    v_dot2c_f32_bf16 v101, v25, v52
    v_dot2c_f32_bf16 v108, v24, v60
    v_dot2c_f32_bf16 v109, v25, v60
    v_dot2c_f32_bf16 v102, v26, v52
    v_dot2c_f32_bf16 v103, v27, v52
    v_dot2c_f32_bf16 v110, v26, v60
    v_dot2c_f32_bf16 v111, v27, v60
    s_waitcnt vmcnt(12)
    s_add_u32 s83, s86, 0
    buffer_load_dwordx4 a[0:3], v1, s[36:39], s83 offen offset:0 nt
    buffer_load_dwordx4 a[4:7], v1, s[36:39], s83 offen offset:1024 nt
    buffer_load_dwordx4 a[8:11], v1, s[36:39], s83 offen offset:2048 nt
    buffer_load_dwordx4 a[12:15], v1, s[36:39], s83 offen offset:3072 nt
    v_perm_b32 v28, v204, v200, s91
    v_perm_b32 v29, v204, v200, s92
    v_perm_b32 v30, v205, v201, s91
    v_perm_b32 v31, v205, v201, s92
    v_perm_b32 v32, v206, v202, s91
    v_perm_b32 v33, v206, v202, s92
    v_perm_b32 v34, v207, v203, s91
    v_perm_b32 v35, v207, v203, s92
    v_dot2c_f32_bf16 v96, v28, v53
    v_dot2c_f32_bf16 v97, v29, v53
    v_dot2c_f32_bf16 v104, v28, v61
    v_dot2c_f32_bf16 v105, v29, v61
    v_dot2c_f32_bf16 v98, v30, v53
    v_dot2c_f32_bf16 v99, v31, v53
    v_dot2c_f32_bf16 v106, v30, v61
    v_dot2c_f32_bf16 v107, v31, v61
    v_dot2c_f32_bf16 v100, v32, v53
    v_dot2c_f32_bf16 v101, v33, v53
    v_dot2c_f32_bf16 v108, v32, v61
    v_dot2c_f32_bf16 v109, v33, v61
    v_dot2c_f32_bf16 v102, v34, v53
    v_dot2c_f32_bf16 v103, v35, v53
    v_dot2c_f32_bf16 v110, v34, v61
    v_dot2c_f32_bf16 v111, v35, v61
    s_waitcnt vmcnt(14)
    v_perm_b32 v20, v212, v208, s91
    v_perm_b32 v21, v212, v208, s92
    v_perm_b32 v22, v213, v209, s91
    v_perm_b32 v23, v213, v209, s92
    v_perm_b32 v24, v214, v210, s91
    v_perm_b32 v25, v214, v210, s92
    v_perm_b32 v26, v215, v211, s91
    v_perm_b32 v27, v215, v211, s92
    v_dot2c_f32_bf16 v96, v20, v54
    v_dot2c_f32_bf16 v97, v21, v54
    v_dot2c_f32_bf16 v104, v20, v62
    v_dot2c_f32_bf16 v105, v21, v62
    v_dot2c_f32_bf16 v98, v22, v54
    v_dot2c_f32_bf16 v99, v23, v54
    v_dot2c_f32_bf16 v106, v22, v62
    v_dot2c_f32_bf16 v107, v23, v62
    v_dot2c_f32_bf16 v100, v24, v54
    v_dot2c_f32_bf16 v101, v25, v54
    v_dot2c_f32_bf16 v108, v24, v62
    v_dot2c_f32_bf16 v109, v25, v62
    v_dot2c_f32_bf16 v102, v26, v54
    v_dot2c_f32_bf16 v103, v27, v54
    v_dot2c_f32_bf16 v110, v26, v62
    v_dot2c_f32_bf16 v111, v27, v62
    s_waitcnt vmcnt(12)
    s_add_u32 s83, s86, 4096
    buffer_load_dwordx4 a[16:19], v1, s[36:39], s83 offen offset:0 nt
    buffer_load_dwordx4 a[20:23], v1, s[36:39], s83 offen offset:1024 nt
    buffer_load_dwordx4 a[24:27], v1, s[36:39], s83 offen offset:2048 nt
    buffer_load_dwordx4 a[28:31], v1, s[36:39], s83 offen offset:3072 nt
    v_perm_b32 v28, v220, v216, s91
    v_perm_b32 v29, v220, v216, s92
    v_perm_b32 v30, v221, v217, s91
    v_perm_b32 v31, v221, v217, s92
    v_perm_b32 v32, v222, v218, s91
    v_perm_b32 v33, v222, v218, s92
    v_perm_b32 v34, v223, v219, s91
    v_perm_b32 v35, v223, v219, s92
    v_dot2c_f32_bf16 v96, v28, v55
    v_dot2c_f32_bf16 v97, v29, v55
    v_dot2c_f32_bf16 v104, v28, v63
    v_dot2c_f32_bf16 v105, v29, v63
    v_dot2c_f32_bf16 v98, v30, v55
    v_dot2c_f32_bf16 v99, v31, v55
    v_dot2c_f32_bf16 v106, v30, v63
    v_dot2c_f32_bf16 v107, v31, v63
    v_dot2c_f32_bf16 v100, v32, v55
    v_dot2c_f32_bf16 v101, v33, v55
    v_dot2c_f32_bf16 v108, v32, v63
    v_dot2c_f32_bf16 v109, v33, v63
    v_dot2c_f32_bf16 v102, v34, v55
    v_dot2c_f32_bf16 v103, v35, v55
    v_dot2c_f32_bf16 v110, v34, v63
    v_dot2c_f32_bf16 v111, v35, v63
    s_waitcnt vmcnt(14)
    v_perm_b32 v20, v228, v224, s91
    v_perm_b32 v21, v228, v224, s92
    v_perm_b32 v22, v229, v225, s91
    v_perm_b32 v23, v229, v225, s92
    v_perm_b32 v24, v230, v226, s91
    v_perm_b32 v25, v230, v226, s92
    v_perm_b32 v26, v231, v227, s91
    v_perm_b32 v27, v231, v227, s92
    v_dot2c_f32_bf16 v96, v20, v56
    v_dot2c_f32_bf16 v97, v21, v56
    v_dot2c_f32_bf16 v104, v20, v64
    v_dot2c_f32_bf16 v105, v21, v64
    v_dot2c_f32_bf16 v98, v22, v56
    v_dot2c_f32_bf16 v99, v23, v56
    v_dot2c_f32_bf16 v106, v22, v64
    v_dot2c_f32_bf16 v107, v23, v64
    v_dot2c_f32_bf16 v100, v24, v56
    v_dot2c_f32_bf16 v101, v25, v56
    v_dot2c_f32_bf16 v108, v24, v64
    v_dot2c_f32_bf16 v109, v25, v64
    v_dot2c_f32_bf16 v102, v26, v56
    v_dot2c_f32_bf16 v103, v27, v56
    v_dot2c_f32_bf16 v110, v26, v64
    v_dot2c_f32_bf16 v111, v27, v64
    s_waitcnt vmcnt(12)
    s_add_u32 s83, s86, 0
    buffer_load_dwordx4 v[128:131], v1, s[40:43], s83 offen offset:0 nt
    buffer_load_dwordx4 v[132:135], v1, s[40:43], s83 offen offset:1024 nt
    buffer_load_dwordx4 v[136:139], v1, s[40:43], s83 offen offset:2048 nt
    buffer_load_dwordx4 v[140:143], v1, s[40:43], s83 offen offset:3072 nt
    v_perm_b32 v28, v236, v232, s91
    v_perm_b32 v29, v236, v232, s92
    v_perm_b32 v30, v237, v233, s91
    v_perm_b32 v31, v237, v233, s92
    v_perm_b32 v32, v238, v234, s91
    v_perm_b32 v33, v238, v234, s92
    v_perm_b32 v34, v239, v235, s91
    v_perm_b32 v35, v239, v235, s92
    v_dot2c_f32_bf16 v96, v28, v57
    v_dot2c_f32_bf16 v97, v29, v57
    v_dot2c_f32_bf16 v104, v28, v65
    v_dot2c_f32_bf16 v105, v29, v65
    v_dot2c_f32_bf16 v98, v30, v57
    v_dot2c_f32_bf16 v99, v31, v57
    v_dot2c_f32_bf16 v106, v30, v65
    v_dot2c_f32_bf16 v107, v31, v65
    v_dot2c_f32_bf16 v100, v32, v57
    v_dot2c_f32_bf16 v101, v33, v57
    v_dot2c_f32_bf16 v108, v32, v65
    v_dot2c_f32_bf16 v109, v33, v65
    v_dot2c_f32_bf16 v102, v34, v57
    v_dot2c_f32_bf16 v103, v35, v57
    v_dot2c_f32_bf16 v110, v34, v65
    v_dot2c_f32_bf16 v111, v35, v65
    s_waitcnt vmcnt(14)
    v_perm_b32 v20, v244, v240, s91
    v_perm_b32 v21, v244, v240, s92
    v_perm_b32 v22, v245, v241, s91
    v_perm_b32 v23, v245, v241, s92
    v_perm_b32 v24, v246, v242, s91
    v_perm_b32 v25, v246, v242, s92
    v_perm_b32 v26, v247, v243, s91
    v_perm_b32 v27, v247, v243, s92
    v_dot2c_f32_bf16 v96, v20, v58
    v_dot2c_f32_bf16 v97, v21, v58
    v_dot2c_f32_bf16 v104, v20, v66
    v_dot2c_f32_bf16 v105, v21, v66
    v_dot2c_f32_bf16 v98, v22, v58
    v_dot2c_f32_bf16 v99, v23, v58
    v_dot2c_f32_bf16 v106, v22, v66
    v_dot2c_f32_bf16 v107, v23, v66
    v_dot2c_f32_bf16 v100, v24, v58
    v_dot2c_f32_bf16 v101, v25, v58
    v_dot2c_f32_bf16 v108, v24, v66
    v_dot2c_f32_bf16 v109, v25, v66
    v_dot2c_f32_bf16 v102, v26, v58
    v_dot2c_f32_bf16 v103, v27, v58
    v_dot2c_f32_bf16 v110, v26, v66
    v_dot2c_f32_bf16 v111, v27, v66
    s_waitcnt vmcnt(12)
    s_add_u32 s83, s86, 4096
    buffer_load_dwordx4 v[144:147], v1, s[40:43], s83 offen offset:0 nt
    buffer_load_dwordx4 v[148:151], v1, s[40:43], s83 offen offset:1024 nt
    buffer_load_dwordx4 v[152:155], v1, s[40:43], s83 offen offset:2048 nt
    buffer_load_dwordx4 v[156:159], v1, s[40:43], s83 offen offset:3072 nt
    v_perm_b32 v28, v252, v248, s91
    v_perm_b32 v29, v252, v248, s92
    v_perm_b32 v30, v253, v249, s91
    v_perm_b32 v31, v253, v249, s92
    v_perm_b32 v32, v254, v250, s91
    v_perm_b32 v33, v254, v250, s92
    v_perm_b32 v34, v255, v251, s91
    v_perm_b32 v35, v255, v251, s92
    v_dot2c_f32_bf16 v96, v28, v59
    v_dot2c_f32_bf16 v97, v29, v59
    v_dot2c_f32_bf16 v104, v28, v67
    v_dot2c_f32_bf16 v105, v29, v67
    v_dot2c_f32_bf16 v98, v30, v59
    v_dot2c_f32_bf16 v99, v31, v59
    v_dot2c_f32_bf16 v106, v30, v67
    v_dot2c_f32_bf16 v107, v31, v67
    v_dot2c_f32_bf16 v100, v32, v59
    v_dot2c_f32_bf16 v101, v33, v59
    v_dot2c_f32_bf16 v108, v32, v67
    v_dot2c_f32_bf16 v109, v33, v67
    v_dot2c_f32_bf16 v102, v34, v59
    v_dot2c_f32_bf16 v103, v35, v59
    v_dot2c_f32_bf16 v110, v34, v67
    v_dot2c_f32_bf16 v111, v35, v67
    v_permlane32_swap_b32 v96, v104
    v_permlane32_swap_b32 v97, v105
    v_permlane32_swap_b32 v98, v106
    v_permlane32_swap_b32 v99, v107
    v_permlane32_swap_b32 v100, v108
    v_permlane32_swap_b32 v101, v109
    v_permlane32_swap_b32 v102, v110
    v_permlane32_swap_b32 v103, v111
    v_add_f32 v96, v96, v104
    v_add_f32 v97, v97, v105
    v_add_f32 v98, v98, v106
    v_add_f32 v99, v99, v107
    v_add_f32 v100, v100, v108
    v_add_f32 v101, v101, v109
    v_add_f32 v102, v102, v110
    v_add_f32 v103, v103, v111
    v_permlane16_swap_b32 v96, v100
    v_permlane16_swap_b32 v97, v101
    v_permlane16_swap_b32 v98, v102
    v_permlane16_swap_b32 v99, v103
    v_add_f32 v96, v96, v100
    v_add_f32 v97, v97, v101
    v_add_f32 v98, v98, v102
    v_add_f32 v99, v99, v103
    v_add_f32_dpp v96, v96, v96 row_ror:8 row_mask:0xf bank_mask:0xf
    v_add_f32_dpp v97, v97, v97 row_ror:8 row_mask:0xf bank_mask:0xf
    v_add_f32_dpp v98, v98, v98 row_ror:8 row_mask:0xf bank_mask:0xf
    v_add_f32_dpp v99, v99, v99 row_ror:8 row_mask:0xf bank_mask:0xf
    s_mov_b64 exec, s[6:7]
    ds_write_b128 v7, v[96:99] offset:8192
    s_mov_b64 exec, 1
    ds_add_rtn_u32 v9, v3, v4 offset:0
    s_mov_b64 exec, -1
    s_waitcnt lgkmcnt(0)
    v_readfirstlane_b32 s83, v9
    s_nop 0
    s_cmp_lg_u32 s83, 3
    s_cbranch_scc1 L_nopub
    ds_read_b128 v[96:99], v1 offset:8192
    ds_read_b128 v[100:103], v1 offset:8704
    ds_read_b128 v[104:107], v1 offset:9216
    ds_read_b128 v[108:111], v1 offset:9728
    s_mov_b32 s83, 512
    s_mov_b32 s84, 1023
    s_waitcnt lgkmcnt(0)
    v_add_f32 v96, v96, v100
    v_add_f32 v97, v97, v101
    v_add_f32 v98, v98, v102
    v_add_f32 v99, v99, v103
    v_add_f32 v104, v104, v108
    v_add_f32 v105, v105, v109
    v_add_f32 v106, v106, v110
    v_add_f32 v107, v107, v111
    v_add_f32 v96, v96, v104
    v_add_f32 v97, v97, v105
    v_add_f32 v98, v98, v106
    v_add_f32 v99, v99, v107
    v_add_u32 v96, s83, v96
    v_add_u32 v97, s83, v97
    v_add_u32 v98, s83, v98
    v_add_u32 v99, s83, v99
    v_bfi_b32 v96, s84, v5, v96
    v_bfi_b32 v97, s84, v5, v97
    v_bfi_b32 v98, s84, v5, v98
    v_bfi_b32 v99, s84, v5, v99
    s_mov_b32 exec_hi, 0
    buffer_store_dwordx4 v[96:99], v8, s[64:67], s32 offen sc1
    s_mov_b64 exec, -1
L_nopub:
    s_nop 3
    s_add_u32 s83, s85, 0
    buffer_load_dwordx4 a[32:35], v1, s[44:47], s83 offen offset:0 nt
    buffer_load_dwordx4 a[36:39], v1, s[44:47], s83 offen offset:1024 nt
    buffer_load_dwordx4 a[40:43], v1, s[44:47], s83 offen offset:2048 nt
    buffer_load_dwordx4 a[44:47], v1, s[44:47], s83 offen offset:3072 nt
    s_add_u32 s83, s85, 4096
    buffer_load_dwordx4 a[48:51], v1, s[44:47], s83 offen offset:0 nt
    buffer_load_dwordx4 a[52:55], v1, s[44:47], s83 offen offset:1024 nt
    buffer_load_dwordx4 a[56:59], v1, s[44:47], s83 offen offset:2048 nt
    buffer_load_dwordx4 a[60:63], v1, s[44:47], s83 offen offset:3072 nt
L_nogate:
    s_nop 3
    s_add_u32 s83, s85, 0
    buffer_load_dwordx4 v[160:163], v1, s[48:51], s83 offen offset:0 nt
    buffer_load_dwordx4 v[164:167], v1, s[48:51], s83 offen offset:1024 nt
    buffer_load_dwordx4 v[168:171], v1, s[48:51], s83 offen offset:2048 nt
    buffer_load_dwordx4 v[172:175], v1, s[48:51], s83 offen offset:3072 nt
    s_add_u32 s83, s85, 4096
    buffer_load_dwordx4 v[176:179], v1, s[48:51], s83 offen offset:0 nt
    buffer_load_dwordx4 v[180:183], v1, s[48:51], s83 offen offset:1024 nt
    buffer_load_dwordx4 v[184:187], v1, s[48:51], s83 offen offset:2048 nt
    buffer_load_dwordx4 v[188:191], v1, s[48:51], s83 offen offset:3072 nt
    v_lshrrev_b32 v9, 4, v0
    v_and_b32 v7, 7, v0
    v_mul_u32_u24 v16, 528, v7
    v_lshl_add_u32 v16, v9, 7, v16
    s_mul_i32 s83, s3, 4224
    v_add_u32 v16, s83, v16
    s_lshl_b32 s83, s3, 3
    v_lshlrev_b32 v17, 5, v7
    v_add_u32 v17, s83, v17
    v_lshrrev_b32 v7, 5, v0
    s_and_b32 s83, s3, 1
    s_lshl_b32 s83, s83, 2
    v_add_u32 v7, s83, v7
    v_mul_u32_u24 v18, 528, v7
    v_and_b32 v8, 31, v0
    v_lshl_add_u32 v18, v8, 4, v18
    v_lshlrev_b32 v19, 5, v7
    v_and_b32 v8, 1, v0
    v_lshl_add_u32 v10, v8, 1, v7
    v_lshlrev_b32 v77, 8, v10
    v_and_b32 v10, 3, v10
    v_lshlrev_b32 v78, 3, v10
    v_bfe_u32 v8, v0, 3, 2
    v_lshl_add_u32 v8, v7, 2, v8
    v_lshlrev_b32 v76, 12, v8
    v_and_b32 v8, 7, v0
    v_lshl_add_u32 v76, v8, 4, v76
    v_lshrrev_b32 v7, 3, v0
    s_cmp_lt_u32 s3, 2
    s_cselect_b32 s83, 5, 8
    v_lshlrev_b32 v79, s83, v7
    s_lshl_b32 s83, s3, 6
    v_lshlrev_b32 v80, 3, v8
    v_add_u32 v80, s83, v80
    v_lshrrev_b32 v87, 5, v0
    v_bfe_u32 v10, v0, 4, 1
    v_lshl_add_u32 v87, v10, 1, v87
    v_lshlrev_b32 v87, 1, v87
    v_add_u32 v80, v80, v87
    v_and_b32 v7, 1, v7
    v_lshlrev_b32 v82, 6, v7
    v_lshl_add_u32 v82, v9, 4, v82
    s_lshr_b32 s83, s3, 1
    s_lshl_b32 s83, s83, 7
    v_add_u32 v82, s83, v82
    v_lshrrev_b32 v7, 5, v0
    v_lshlrev_b32 v81, 20, v7
    v_bfe_u32 v7, v0, 1, 3
    v_lshl_add_u32 v81, v7, 14, v81
    v_and_b32 v7, 1, v0
    v_lshl_add_u32 v81, v7, 5, v81
    v_and_b32 v7, 16, v0
    v_add_u32 v81, v81, v7
    s_mov_b32 s54, 0
    s_lshr_b32 s52, s2, 5
    s_lshl_b32 s52, s52, 23
    s_lshl_b32 s83, s3, 13
    s_add_u32 s52, s52, s83
    s_add_u32 s52, s52, 196608
    s_mov_b32 s55, 128
    s_cmp_lt_u32 s3, 2
    s_cselect_b32 s55, s55, 128
    s_add_u32 s83, s85, 32768
    buffer_load_dwordx4 a[64:67], v1, s[44:47], s83 offen offset:0 nt
    buffer_load_dwordx4 a[68:71], v1, s[44:47], s83 offen offset:1024 nt
    buffer_load_dwordx4 a[72:75], v1, s[44:47], s83 offen offset:2048 nt
    buffer_load_dwordx4 a[76:79], v1, s[44:47], s83 offen offset:3072 nt
    s_add_u32 s83, s85, 36864
    buffer_load_dwordx4 a[80:83], v1, s[44:47], s83 offen offset:0 nt
    buffer_load_dwordx4 a[84:87], v1, s[44:47], s83 offen offset:1024 nt
    buffer_load_dwordx4 a[88:91], v1, s[44:47], s83 offen offset:2048 nt
    buffer_load_dwordx4 a[92:95], v1, s[44:47], s83 offen offset:3072 nt
    s_add_u32 s83, s85, 32768
    buffer_load_dwordx4 v[192:195], v1, s[48:51], s83 offen offset:0 nt
    buffer_load_dwordx4 v[196:199], v1, s[48:51], s83 offen offset:1024 nt
    buffer_load_dwordx4 v[200:203], v1, s[48:51], s83 offen offset:2048 nt
    buffer_load_dwordx4 v[204:207], v1, s[48:51], s83 offen offset:3072 nt
    s_add_u32 s83, s85, 36864
    buffer_load_dwordx4 v[208:211], v1, s[48:51], s83 offen offset:0 nt
    buffer_load_dwordx4 v[212:215], v1, s[48:51], s83 offen offset:1024 nt
    buffer_load_dwordx4 v[216:219], v1, s[48:51], s83 offen offset:2048 nt
    buffer_load_dwordx4 v[220:223], v1, s[48:51], s83 offen offset:3072 nt
    s_add_u32 s83, s33, 0x8000
    buffer_load_dwordx4 v[52:55], v1, s[64:67], s33 offen offset:0
    buffer_load_dwordx4 v[56:59], v1, s[64:67], s33 offen offset:1024
    buffer_load_dwordx4 v[60:63], v1, s[64:67], s83 offen offset:0
    buffer_load_dwordx4 v[64:67], v1, s[64:67], s83 offen offset:1024
    s_add_u32 s83, s85, 65536
    buffer_load_dwordx4 a[96:99], v1, s[44:47], s83 offen offset:0 nt
    buffer_load_dwordx4 a[100:103], v1, s[44:47], s83 offen offset:1024 nt
    buffer_load_dwordx4 a[104:107], v1, s[44:47], s83 offen offset:2048 nt
    buffer_load_dwordx4 a[108:111], v1, s[44:47], s83 offen offset:3072 nt
    s_add_u32 s83, s85, 69632
    buffer_load_dwordx4 a[112:115], v1, s[44:47], s83 offen offset:0 nt
    buffer_load_dwordx4 a[116:119], v1, s[44:47], s83 offen offset:1024 nt
    buffer_load_dwordx4 a[120:123], v1, s[44:47], s83 offen offset:2048 nt
    buffer_load_dwordx4 a[124:127], v1, s[44:47], s83 offen offset:3072 nt
    s_add_u32 s83, s85, 65536
    buffer_load_dwordx4 v[224:227], v1, s[48:51], s83 offen offset:0 nt
    buffer_load_dwordx4 v[228:231], v1, s[48:51], s83 offen offset:1024 nt
    s_waitcnt vmcnt(62)
    buffer_load_dwordx4 v[232:235], v1, s[48:51], s83 offen offset:2048 nt
    s_waitcnt vmcnt(62)
    buffer_load_dwordx4 v[236:239], v1, s[48:51], s83 offen offset:3072 nt
    s_and_b32 s32, s89, 1023
    s_waitcnt vmcnt(12)
    s_mov_b32 s100, 16384
    s_nop 1
L_chk_q:
    v_xor_b32 v52, s32, v52
    v_xor_b32 v53, s32, v53
    v_xor_b32 v54, s32, v54
    v_xor_b32 v55, s32, v55
    v_xor_b32 v56, s32, v56
    v_xor_b32 v57, s32, v57
    v_xor_b32 v58, s32, v58
    v_xor_b32 v59, s32, v59
    v_xor_b32 v60, s32, v60
    v_xor_b32 v61, s32, v61
    v_xor_b32 v62, s32, v62
    v_xor_b32 v63, s32, v63
    v_xor_b32 v64, s32, v64
    v_xor_b32 v65, s32, v65
    v_xor_b32 v66, s32, v66
    v_xor_b32 v67, s32, v67
    v_or_b32 v7, v52, v53
    v_or3_b32 v7, v7, v54, v55
    v_or3_b32 v7, v7, v56, v57
    v_or3_b32 v7, v7, v58, v59
    v_or3_b32 v7, v7, v60, v61
    v_or3_b32 v7, v7, v62, v63
    v_or3_b32 v7, v7, v64, v65
    v_or3_b32 v7, v7, v66, v67
    v_and_b32 v7, 1023, v7
    v_cmp_ne_u32 vcc, 0, v7
    s_nop 4
    s_cbranch_vccz L_ok_q
    s_sub_u32 s100, s100, 1
    s_cbranch_scc1 L_ok_q
    s_mov_b64 exec, vcc
    s_add_u32 s83, s33, 0x8000
    buffer_load_dwordx4 v[52:55], v1, s[64:67], s33 offen offset:0 sc1
    buffer_load_dwordx4 v[56:59], v1, s[64:67], s33 offen offset:1024 sc1
    buffer_load_dwordx4 v[60:63], v1, s[64:67], s83 offen offset:0 sc1
    buffer_load_dwordx4 v[64:67], v1, s[64:67], s83 offen offset:1024 sc1
    s_waitcnt vmcnt(0)
    s_branch L_chk_q
L_ok_q:
    s_mov_b64 exec, -1
    v_add_f32 v52, v52, v60
    v_add_f32 v53, v53, v61
    v_add_f32 v54, v54, v62
    v_add_f32 v55, v55, v63
    v_add_f32 v56, v56, v64
    v_add_f32 v57, v57, v65
    v_add_f32 v58, v58, v66
    v_add_f32 v59, v59, v67
    v_cvt_pk_bf16_f32 v60, v52, v53
    v_cvt_pk_bf16_f32 v61, v54, v55
    v_cvt_pk_bf16_f32 v62, v56, v57
    v_cvt_pk_bf16_f32 v63, v58, v59
    v_lshrrev_b32 v7, 5, v0
    v_mul_u32_u24 v7, 272, v7
    v_and_b32 v8, 31, v0
    v_lshl_add_u32 v7, v8, 3, v7
    s_lshr_b32 s83, s3, 1
    s_mul_i32 s83, s83, 2176
    s_and_b32 s84, s3, 1
    s_mul_i32 s84, s84, 1088
    s_add_u32 s83, s83, s84
    v_add_u32 v7, s83, v7
    ds_write_b64 v7, v[60:61] offset:0
    ds_write_b64 v7, v[62:63] offset:544
    s_mov_b64 exec, 1
    ds_add_u32 v3, v4 offset:4
    s_mov_b64 exec, -1
    v_and_b32 v8, 7, v0
    v_mul_u32_u24 v8, 272, v8
    v_lshrrev_b32 v9, 4, v0
    v_lshl_add_u32 v8, v9, 4, v8
    s_add_u32 s83, s85, 69632
    buffer_load_dwordx4 v[240:243], v1, s[48:51], s83 offen offset:0 nt
    buffer_load_dwordx4 v[244:247], v1, s[48:51], s83 offen offset:1024 nt
    buffer_load_dwordx4 v[248:251], v1, s[48:51], s83 offen offset:2048 nt
    buffer_load_dwordx4 v[252:255], v1, s[48:51], s83 offen offset:3072 nt
    s_waitcnt lgkmcnt(0)
L_aw_q:
    ds_read_b32 v7, v3 offset:4
    s_waitcnt lgkmcnt(0)
    v_readfirstlane_b32 s83, v7
    s_nop 0
    s_cmp_lt_u32 s83, 4
    s_cbranch_scc1 L_aw_q
    ds_read_b128 a[128:131], v8 offset:0
    ds_read_b128 a[132:135], v8 offset:64
    ds_read_b128 a[136:139], v8 offset:128
    ds_read_b128 a[140:143], v8 offset:192
    ds_read_b128 a[144:147], v8 offset:2176
    ds_read_b128 a[148:151], v8 offset:2240
    ds_read_b128 a[152:155], v8 offset:2304
    ds_read_b128 a[156:159], v8 offset:2368
    s_waitcnt lgkmcnt(0)
    ds_write_b128 v83, a[0:3] offset:0
    ds_write_b128 v83, a[4:7] offset:1088
    ds_write_b128 v83, a[8:11] offset:2176
    ds_write_b128 v83, a[12:15] offset:3264
    ds_write_b128 v83, a[16:19] offset:4352
    ds_write_b128 v83, a[20:23] offset:5440
    ds_write_b128 v83, a[24:27] offset:6528
    ds_write_b128 v83, a[28:31] offset:7616
    ds_read_b128 a[160:163], v84 offset:0
    ds_read_b128 a[176:179], v84 offset:4352
    ds_read_b128 a[164:167], v84 offset:64
    ds_read_b128 a[180:183], v84 offset:4416
    ds_read_b128 a[168:171], v84 offset:128
    ds_read_b128 a[184:187], v84 offset:4480
    ds_read_b128 a[172:175], v84 offset:192
    ds_read_b128 a[188:191], v84 offset:4544
    s_add_u32 s83, s85, 98304
    buffer_load_dwordx4 a[0:3], v1, s[44:47], s83 offen offset:0 nt
    buffer_load_dwordx4 a[4:7], v1, s[44:47], s83 offen offset:1024 nt
    buffer_load_dwordx4 a[8:11], v1, s[44:47], s83 offen offset:2048 nt
    buffer_load_dwordx4 a[12:15], v1, s[44:47], s83 offen offset:3072 nt
    s_waitcnt lgkmcnt(0)
    v_mfma_f32_16x16x32_bf16 v[20:23], a[160:163], a[128:131], 0
    v_mfma_f32_16x16x32_bf16 v[24:27], a[176:179], a[128:131], 0
    v_mfma_f32_16x16x32_bf16 v[20:23], a[164:167], a[132:135], v[20:23]
    v_mfma_f32_16x16x32_bf16 v[24:27], a[180:183], a[132:135], v[24:27]
    v_mfma_f32_16x16x32_bf16 v[20:23], a[168:171], a[136:139], v[20:23]
    v_mfma_f32_16x16x32_bf16 v[24:27], a[184:187], a[136:139], v[24:27]
    v_mfma_f32_16x16x32_bf16 v[20:23], a[172:175], a[140:143], v[20:23]
    v_mfma_f32_16x16x32_bf16 v[24:27], a[188:191], a[140:143], v[24:27]
    s_nop 6
    v_cvt_pk_bf16_f32 v32, v20, v21
    v_cvt_pk_bf16_f32 v33, v22, v23
    v_cvt_pk_bf16_f32 v34, v24, v25
    v_cvt_pk_bf16_f32 v35, v26, v27
    v_lshlrev_b32 v20, 16, v32
    v_and_b32 v21, s98, v32
    v_lshlrev_b32 v22, 16, v33
    v_and_b32 v23, s98, v33
    v_lshlrev_b32 v24, 16, v34
    v_and_b32 v25, s98, v34
    v_lshlrev_b32 v26, 16, v35
    v_and_b32 v27, s98, v35
    v_pk_mul_f32 v[20:21], v[20:21], s[4:5]
    v_pk_mul_f32 v[22:23], v[22:23], s[4:5]
    v_pk_mul_f32 v[24:25], v[24:25], s[4:5]
    v_pk_mul_f32 v[26:27], v[26:27], s[4:5]
    v_cvt_pk_bf16_f32 v32, v20, v21
    v_cvt_pk_bf16_f32 v33, v22, v23
    v_cvt_pk_bf16_f32 v34, v24, v25
    v_cvt_pk_bf16_f32 v35, v26, v27
    v_lshlrev_b32 v20, 16, v32
    v_and_b32 v21, s98, v32
    v_lshlrev_b32 v22, 16, v33
    v_and_b32 v23, s98, v33
    v_lshlrev_b32 v24, 16, v34
    v_and_b32 v25, s98, v34
    v_lshlrev_b32 v26, 16, v35
    v_and_b32 v27, s98, v35
    v_max3_f32 v7, v20, v21, v22
    v_max3_f32 v8, v23, v24, v25
    v_max3_f32 v7, v7, v26, v27
    v_max_f32 v11, v7, v8
    v_mov_b32 v8, v11
    s_nop 1
    v_permlane32_swap_b32 v11, v8
    v_max_f32 v11, v11, v8
    v_mov_b32 v8, v11
    s_nop 1
    v_permlane16_swap_b32 v11, v8
    v_max_f32 v11, v11, v8
    v_mul_f32 v12, s93, v11
    v_fma_f32 v20, v20, s93, -v12
    v_fma_f32 v21, v21, s93, -v12
    v_fma_f32 v22, v22, s93, -v12
    v_fma_f32 v23, v23, s93, -v12
    v_fma_f32 v24, v24, s93, -v12
    v_fma_f32 v25, v25, s93, -v12
    v_fma_f32 v26, v26, s93, -v12
    v_fma_f32 v27, v27, s93, -v12
    v_exp_f32 v20, v20
    v_exp_f32 v21, v21
    v_exp_f32 v22, v22
    v_exp_f32 v23, v23
    v_exp_f32 v24, v24
    v_exp_f32 v25, v25
    v_exp_f32 v26, v26
    v_exp_f32 v27, v27
    v_cvt_pk_bf16_f32 v28, v20, v21
    v_cvt_pk_bf16_f32 v29, v22, v23
    v_cvt_pk_bf16_f32 v30, v24, v25
    v_cvt_pk_bf16_f32 v31, v26, v27
    v_add_f32 v7, v20, v21
    v_add_f32 v8, v22, v23
    v_add_f32 v9, v24, v25
    v_add_f32 v10, v26, v27
    v_add_f32 v7, v7, v8
    v_add_f32 v9, v9, v10
    v_add_f32 v13, v7, v9
    v_mov_b32 v8, v13
    s_nop 1
    v_permlane32_swap_b32 v13, v8
    v_add_f32 v13, v13, v8
    v_mov_b32 v8, v13
    s_nop 1
    v_permlane16_swap_b32 v13, v8
    v_add_f32 v13, v13, v8
    v_mov_b32 v8, v11
    v_mov_b32 v9, v13
    s_mov_b64 exec, 0xff
    ds_write_b64 v17, v[8:9] offset:5120
    s_mov_b64 exec, -1
    s_mov_b32 s6, 0x00ff00ff
    s_mov_b32 s7, 0x00ff00ff
    v_perm_b32 v36, v132, v128, s91
    v_perm_b32 v40, v132, v128, s92
    v_perm_b32 v37, v140, v136, s91
    v_perm_b32 v41, v140, v136, s92
    v_perm_b32 v38, v148, v144, s91
    v_perm_b32 v42, v148, v144, s92
    v_perm_b32 v39, v156, v152, s91
    v_perm_b32 v43, v156, v152, s92
    v_perm_b32 v44, v133, v129, s91
    v_perm_b32 v48, v133, v129, s92
    v_perm_b32 v45, v141, v137, s91
    v_perm_b32 v49, v141, v137, s92
    v_perm_b32 v46, v149, v145, s91
    v_perm_b32 v50, v149, v145, s92
    v_perm_b32 v47, v157, v153, s91
    v_perm_b32 v51, v157, v153, s92
    v_mfma_f32_16x16x32_bf16 v[96:99], v[36:39], v[28:31], 0
    v_mfma_f32_16x16x32_bf16 v[100:103], v[40:43], v[28:31], 0
    v_perm_b32 v36, v134, v130, s91
    v_perm_b32 v40, v134, v130, s92
    v_perm_b32 v37, v142, v138, s91
    v_perm_b32 v41, v142, v138, s92
    v_perm_b32 v38, v150, v146, s91
    v_perm_b32 v42, v150, v146, s92
    v_perm_b32 v39, v158, v154, s91
    v_perm_b32 v43, v158, v154, s92
    v_mfma_f32_16x16x32_bf16 v[104:107], v[44:47], v[28:31], 0
    v_mfma_f32_16x16x32_bf16 v[108:111], v[48:51], v[28:31], 0
    v_perm_b32 v44, v135, v131, s91
    v_perm_b32 v48, v135, v131, s92
    v_perm_b32 v45, v143, v139, s91
    v_perm_b32 v49, v143, v139, s92
    v_perm_b32 v46, v151, v147, s91
    v_perm_b32 v50, v151, v147, s92
    v_perm_b32 v47, v159, v155, s91
    v_perm_b32 v51, v159, v155, s92
    v_mfma_f32_16x16x32_bf16 v[112:115], v[36:39], v[28:31], 0
    v_mfma_f32_16x16x32_bf16 v[116:119], v[40:43], v[28:31], 0
    v_mfma_f32_16x16x32_bf16 v[120:123], v[44:47], v[28:31], 0
    v_mfma_f32_16x16x32_bf16 v[124:127], v[48:51], v[28:31], 0
    s_mov_b64 exec, s[6:7]
    ds_write_b128 v16, v[96:99] offset:8192
    ds_write_b128 v16, v[100:103] offset:8208
    ds_write_b128 v16, v[104:107] offset:8224
    ds_write_b128 v16, v[108:111] offset:8240
    ds_write_b128 v16, v[112:115] offset:8256
    ds_write_b128 v16, v[116:119] offset:8272
    ds_write_b128 v16, v[120:123] offset:8288
    ds_write_b128 v16, v[124:127] offset:8304
    s_mov_b64 exec, 1
    ds_add_u32 v3, v4 offset:8
    s_mov_b64 exec, -1
    s_add_u32 s83, s85, 102400
    buffer_load_dwordx4 a[16:19], v1, s[44:47], s83 offen offset:0 nt
    buffer_load_dwordx4 a[20:23], v1, s[44:47], s83 offen offset:1024 nt
    buffer_load_dwordx4 a[24:27], v1, s[44:47], s83 offen offset:2048 nt
    buffer_load_dwordx4 a[28:31], v1, s[44:47], s83 offen offset:3072 nt
    ds_write_b128 v83, a[32:35] offset:0
    ds_write_b128 v83, a[36:39] offset:1088
    ds_write_b128 v83, a[40:43] offset:2176
    ds_write_b128 v83, a[44:47] offset:3264
    ds_write_b128 v83, a[48:51] offset:4352
    ds_write_b128 v83, a[52:55] offset:5440
    ds_write_b128 v83, a[56:59] offset:6528
    ds_write_b128 v83, a[60:63] offset:7616
    ds_read_b128 a[160:163], v84 offset:0
    ds_read_b128 a[176:179], v84 offset:4352
    ds_read_b128 a[164:167], v84 offset:64
    ds_read_b128 a[180:183], v84 offset:4416
    ds_read_b128 a[168:171], v84 offset:128
    ds_read_b128 a[184:187], v84 offset:4480
    ds_read_b128 a[172:175], v84 offset:192
    ds_read_b128 a[188:191], v84 offset:4544
    s_add_u32 s83, s85, 98304
    buffer_load_dwordx4 v[128:131], v1, s[48:51], s83 offen offset:0 nt
    buffer_load_dwordx4 v[132:135], v1, s[48:51], s83 offen offset:1024 nt
    buffer_load_dwordx4 v[136:139], v1, s[48:51], s83 offen offset:2048 nt
    buffer_load_dwordx4 v[140:143], v1, s[48:51], s83 offen offset:3072 nt
    s_waitcnt lgkmcnt(0)
    v_mfma_f32_16x16x32_bf16 v[20:23], a[160:163], a[144:147], 0
    v_mfma_f32_16x16x32_bf16 v[24:27], a[176:179], a[144:147], 0
    v_mfma_f32_16x16x32_bf16 v[20:23], a[164:167], a[148:151], v[20:23]
    v_mfma_f32_16x16x32_bf16 v[24:27], a[180:183], a[148:151], v[24:27]
    v_mfma_f32_16x16x32_bf16 v[20:23], a[168:171], a[152:155], v[20:23]
    v_mfma_f32_16x16x32_bf16 v[24:27], a[184:187], a[152:155], v[24:27]
    v_mfma_f32_16x16x32_bf16 v[20:23], a[172:175], a[156:159], v[20:23]
    v_mfma_f32_16x16x32_bf16 v[24:27], a[188:191], a[156:159], v[24:27]
    s_nop 6
    v_cvt_pk_bf16_f32 v32, v20, v21
    v_cvt_pk_bf16_f32 v33, v22, v23
    v_cvt_pk_bf16_f32 v34, v24, v25
    v_cvt_pk_bf16_f32 v35, v26, v27
    v_lshlrev_b32 v20, 16, v32
    v_and_b32 v21, s98, v32
    v_lshlrev_b32 v22, 16, v33
    v_and_b32 v23, s98, v33
    v_lshlrev_b32 v24, 16, v34
    v_and_b32 v25, s98, v34
    v_lshlrev_b32 v26, 16, v35
    v_and_b32 v27, s98, v35
    v_pk_mul_f32 v[20:21], v[20:21], s[4:5]
    v_pk_mul_f32 v[22:23], v[22:23], s[4:5]
    v_pk_mul_f32 v[24:25], v[24:25], s[4:5]
    v_pk_mul_f32 v[26:27], v[26:27], s[4:5]
    v_cvt_pk_bf16_f32 v32, v20, v21
    v_cvt_pk_bf16_f32 v33, v22, v23
    v_cvt_pk_bf16_f32 v34, v24, v25
    v_cvt_pk_bf16_f32 v35, v26, v27
    v_lshlrev_b32 v20, 16, v32
    v_and_b32 v21, s98, v32
    v_lshlrev_b32 v22, 16, v33
    v_and_b32 v23, s98, v33
    v_lshlrev_b32 v24, 16, v34
    v_and_b32 v25, s98, v34
    v_lshlrev_b32 v26, 16, v35
    v_and_b32 v27, s98, v35
    v_max3_f32 v7, v20, v21, v22
    v_max3_f32 v8, v23, v24, v25
    v_max3_f32 v7, v7, v26, v27
    v_max_f32 v11, v7, v8
    v_mov_b32 v8, v11
    s_nop 1
    v_permlane32_swap_b32 v11, v8
    v_max_f32 v11, v11, v8
    v_mov_b32 v8, v11
    s_nop 1
    v_permlane16_swap_b32 v11, v8
    v_max_f32 v11, v11, v8
    v_mul_f32 v12, s93, v11
    v_fma_f32 v20, v20, s93, -v12
    v_fma_f32 v21, v21, s93, -v12
    v_fma_f32 v22, v22, s93, -v12
    v_fma_f32 v23, v23, s93, -v12
    v_fma_f32 v24, v24, s93, -v12
    v_fma_f32 v25, v25, s93, -v12
    v_fma_f32 v26, v26, s93, -v12
    v_fma_f32 v27, v27, s93, -v12
    v_exp_f32 v20, v20
    v_exp_f32 v21, v21
    v_exp_f32 v22, v22
    v_exp_f32 v23, v23
    v_exp_f32 v24, v24
    v_exp_f32 v25, v25
    v_exp_f32 v26, v26
    v_exp_f32 v27, v27
    v_cvt_pk_bf16_f32 v28, v20, v21
    v_cvt_pk_bf16_f32 v29, v22, v23
    v_cvt_pk_bf16_f32 v30, v24, v25
    v_cvt_pk_bf16_f32 v31, v26, v27
    v_add_f32 v7, v20, v21
    v_add_f32 v8, v22, v23
    v_add_f32 v9, v24, v25
    v_add_f32 v10, v26, v27
    v_add_f32 v7, v7, v8
    v_add_f32 v9, v9, v10
    v_add_f32 v13, v7, v9
    v_perm_b32 v36, v164, v160, s91
    v_perm_b32 v40, v164, v160, s92
    v_perm_b32 v37, v172, v168, s91
    v_perm_b32 v41, v172, v168, s92
    v_perm_b32 v38, v180, v176, s91
    v_perm_b32 v42, v180, v176, s92
    v_perm_b32 v39, v188, v184, s91
    v_perm_b32 v43, v188, v184, s92
    v_perm_b32 v44, v165, v161, s91
    v_perm_b32 v48, v165, v161, s92
    v_perm_b32 v45, v173, v169, s91
    v_perm_b32 v49, v173, v169, s92
    v_perm_b32 v46, v181, v177, s91
    v_perm_b32 v50, v181, v177, s92
    v_perm_b32 v47, v189, v185, s91
    v_perm_b32 v51, v189, v185, s92
    v_mfma_f32_16x16x32_bf16 v[96:99], v[36:39], v[28:31], 0
    v_mfma_f32_16x16x32_bf16 v[100:103], v[40:43], v[28:31], 0
    v_perm_b32 v36, v166, v162, s91
    v_perm_b32 v40, v166, v162, s92
    v_perm_b32 v37, v174, v170, s91
    v_perm_b32 v41, v174, v170, s92
    v_perm_b32 v38, v182, v178, s91
    v_perm_b32 v42, v182, v178, s92
    v_perm_b32 v39, v190, v186, s91
    v_perm_b32 v43, v190, v186, s92
    v_mfma_f32_16x16x32_bf16 v[104:107], v[44:47], v[28:31], 0
    v_mfma_f32_16x16x32_bf16 v[108:111], v[48:51], v[28:31], 0
    v_perm_b32 v44, v167, v163, s91
    v_perm_b32 v48, v167, v163, s92
    v_perm_b32 v45, v175, v171, s91
    v_perm_b32 v49, v175, v171, s92
    v_perm_b32 v46, v183, v179, s91
    v_perm_b32 v50, v183, v179, s92
    v_perm_b32 v47, v191, v187, s91
    v_perm_b32 v51, v191, v187, s92
    v_mfma_f32_16x16x32_bf16 v[112:115], v[36:39], v[28:31], 0
    v_mfma_f32_16x16x32_bf16 v[116:119], v[40:43], v[28:31], 0
    v_mfma_f32_16x16x32_bf16 v[120:123], v[44:47], v[28:31], 0
    v_mfma_f32_16x16x32_bf16 v[124:127], v[48:51], v[28:31], 0
    s_add_u32 s83, s85, 102400
    buffer_load_dwordx4 v[144:147], v1, s[48:51], s83 offen offset:0 nt
    buffer_load_dwordx4 v[148:151], v1, s[48:51], s83 offen offset:1024 nt
    buffer_load_dwordx4 v[152:155], v1, s[48:51], s83 offen offset:2048 nt
    buffer_load_dwordx4 v[156:159], v1, s[48:51], s83 offen offset:3072 nt
    ds_write_b128 v83, a[64:67] offset:0
    ds_write_b128 v83, a[68:71] offset:1088
    ds_write_b128 v83, a[72:75] offset:2176
    ds_write_b128 v83, a[76:79] offset:3264
    ds_write_b128 v83, a[80:83] offset:4352
    ds_write_b128 v83, a[84:87] offset:5440
    ds_write_b128 v83, a[88:91] offset:6528
    ds_write_b128 v83, a[92:95] offset:7616
    ds_read_b128 a[160:163], v84 offset:0
    ds_read_b128 a[176:179], v84 offset:4352
    ds_read_b128 a[164:167], v84 offset:64
    ds_read_b128 a[180:183], v84 offset:4416
    ds_read_b128 a[168:171], v84 offset:128
    ds_read_b128 a[184:187], v84 offset:4480
    ds_read_b128 a[172:175], v84 offset:192
    ds_read_b128 a[188:191], v84 offset:4544
    s_add_u32 s83, s85, 131072
    buffer_load_dwordx4 a[32:35], v1, s[44:47], s83 offen offset:0 nt
    buffer_load_dwordx4 a[36:39], v1, s[44:47], s83 offen offset:1024 nt
    buffer_load_dwordx4 a[40:43], v1, s[44:47], s83 offen offset:2048 nt
    buffer_load_dwordx4 a[44:47], v1, s[44:47], s83 offen offset:3072 nt
    s_waitcnt lgkmcnt(0)
    v_mfma_f32_16x16x32_bf16 v[20:23], a[160:163], a[144:147], 0
    v_mfma_f32_16x16x32_bf16 v[24:27], a[176:179], a[144:147], 0
    v_mfma_f32_16x16x32_bf16 v[20:23], a[164:167], a[148:151], v[20:23]
    v_mfma_f32_16x16x32_bf16 v[24:27], a[180:183], a[148:151], v[24:27]
    v_mfma_f32_16x16x32_bf16 v[20:23], a[168:171], a[152:155], v[20:23]
    v_mfma_f32_16x16x32_bf16 v[24:27], a[184:187], a[152:155], v[24:27]
    v_mfma_f32_16x16x32_bf16 v[20:23], a[172:175], a[156:159], v[20:23]
    v_mfma_f32_16x16x32_bf16 v[24:27], a[188:191], a[156:159], v[24:27]
    s_nop 6
    v_cvt_pk_bf16_f32 v32, v20, v21
    v_cvt_pk_bf16_f32 v33, v22, v23
    v_cvt_pk_bf16_f32 v34, v24, v25
    v_cvt_pk_bf16_f32 v35, v26, v27
    v_lshlrev_b32 v20, 16, v32
    v_and_b32 v21, s98, v32
    v_lshlrev_b32 v22, 16, v33
    v_and_b32 v23, s98, v33
    v_lshlrev_b32 v24, 16, v34
    v_and_b32 v25, s98, v34
    v_lshlrev_b32 v26, 16, v35
    v_and_b32 v27, s98, v35
    v_pk_mul_f32 v[20:21], v[20:21], s[4:5]
    v_pk_mul_f32 v[22:23], v[22:23], s[4:5]
    v_pk_mul_f32 v[24:25], v[24:25], s[4:5]
    v_pk_mul_f32 v[26:27], v[26:27], s[4:5]
    v_cvt_pk_bf16_f32 v32, v20, v21
    v_cvt_pk_bf16_f32 v33, v22, v23
    v_cvt_pk_bf16_f32 v34, v24, v25
    v_cvt_pk_bf16_f32 v35, v26, v27
    v_lshlrev_b32 v20, 16, v32
    v_and_b32 v21, s98, v32
    v_lshlrev_b32 v22, 16, v33
    v_and_b32 v23, s98, v33
    v_lshlrev_b32 v24, 16, v34
    v_and_b32 v25, s98, v34
    v_lshlrev_b32 v26, 16, v35
    v_and_b32 v27, s98, v35
    v_max3_f32 v7, v20, v21, v22
    v_max3_f32 v8, v23, v24, v25
    v_max3_f32 v7, v7, v26, v27
    v_max3_f32 v11, v7, v8, v11
    v_mov_b32 v8, v11
    s_nop 1
    v_permlane32_swap_b32 v11, v8
    v_max_f32 v11, v11, v8
    v_mov_b32 v8, v11
    s_nop 1
    v_permlane16_swap_b32 v11, v8
    v_max_f32 v11, v11, v8
    v_mov_b32 v9, v12
    v_mul_f32 v12, s93, v11
    v_sub_f32 v9, v9, v12
    v_exp_f32 v14, v9
    v_fma_f32 v20, v20, s93, -v12
    v_fma_f32 v21, v21, s93, -v12
    v_fma_f32 v22, v22, s93, -v12
    v_fma_f32 v23, v23, s93, -v12
    v_fma_f32 v24, v24, s93, -v12
    v_fma_f32 v25, v25, s93, -v12
    v_fma_f32 v26, v26, s93, -v12
    v_fma_f32 v27, v27, s93, -v12
    v_exp_f32 v20, v20
    v_exp_f32 v21, v21
    v_exp_f32 v22, v22
    v_exp_f32 v23, v23
    v_exp_f32 v24, v24
    v_exp_f32 v25, v25
    v_exp_f32 v26, v26
    v_exp_f32 v27, v27
    v_pk_mul_f32 v[96:97], v[96:97], v[14:15] op_sel_hi:[1,0]
    v_pk_mul_f32 v[98:99], v[98:99], v[14:15] op_sel_hi:[1,0]
    v_pk_mul_f32 v[100:101], v[100:101], v[14:15] op_sel_hi:[1,0]
    v_pk_mul_f32 v[102:103], v[102:103], v[14:15] op_sel_hi:[1,0]
    v_pk_mul_f32 v[104:105], v[104:105], v[14:15] op_sel_hi:[1,0]
    v_pk_mul_f32 v[106:107], v[106:107], v[14:15] op_sel_hi:[1,0]
    v_pk_mul_f32 v[108:109], v[108:109], v[14:15] op_sel_hi:[1,0]
    v_pk_mul_f32 v[110:111], v[110:111], v[14:15] op_sel_hi:[1,0]
    v_pk_mul_f32 v[112:113], v[112:113], v[14:15] op_sel_hi:[1,0]
    v_pk_mul_f32 v[114:115], v[114:115], v[14:15] op_sel_hi:[1,0]
    v_pk_mul_f32 v[116:117], v[116:117], v[14:15] op_sel_hi:[1,0]
    v_pk_mul_f32 v[118:119], v[118:119], v[14:15] op_sel_hi:[1,0]
    v_pk_mul_f32 v[120:121], v[120:121], v[14:15] op_sel_hi:[1,0]
    v_pk_mul_f32 v[122:123], v[122:123], v[14:15] op_sel_hi:[1,0]
    v_pk_mul_f32 v[124:125], v[124:125], v[14:15] op_sel_hi:[1,0]
    v_pk_mul_f32 v[126:127], v[126:127], v[14:15] op_sel_hi:[1,0]
    v_cvt_pk_bf16_f32 v28, v20, v21
    v_cvt_pk_bf16_f32 v29, v22, v23
    v_cvt_pk_bf16_f32 v30, v24, v25
    v_cvt_pk_bf16_f32 v31, v26, v27
    v_add_f32 v7, v20, v21
    v_add_f32 v8, v22, v23
    v_add_f32 v9, v24, v25
    v_add_f32 v10, v26, v27
    v_add_f32 v7, v7, v8
    v_add_f32 v9, v9, v10
    v_add_f32 v7, v7, v9
    v_fma_f32 v13, v13, v14, v7
    v_perm_b32 v36, v196, v192, s91
    v_perm_b32 v40, v196, v192, s92
    v_perm_b32 v37, v204, v200, s91
    v_perm_b32 v41, v204, v200, s92
    v_perm_b32 v38, v212, v208, s91
    v_perm_b32 v42, v212, v208, s92
    v_perm_b32 v39, v220, v216, s91
    v_perm_b32 v43, v220, v216, s92
    v_perm_b32 v44, v197, v193, s91
    v_perm_b32 v48, v197, v193, s92
    v_perm_b32 v45, v205, v201, s91
    v_perm_b32 v49, v205, v201, s92
    v_perm_b32 v46, v213, v209, s91
    v_perm_b32 v50, v213, v209, s92
    v_perm_b32 v47, v221, v217, s91
    v_perm_b32 v51, v221, v217, s92
    v_mfma_f32_16x16x32_bf16 v[96:99], v[36:39], v[28:31], v[96:99]
    v_mfma_f32_16x16x32_bf16 v[100:103], v[40:43], v[28:31], v[100:103]
    v_perm_b32 v36, v198, v194, s91
    v_perm_b32 v40, v198, v194, s92
    v_perm_b32 v37, v206, v202, s91
    v_perm_b32 v41, v206, v202, s92
    v_perm_b32 v38, v214, v210, s91
    v_perm_b32 v42, v214, v210, s92
    v_perm_b32 v39, v222, v218, s91
    v_perm_b32 v43, v222, v218, s92
    v_mfma_f32_16x16x32_bf16 v[104:107], v[44:47], v[28:31], v[104:107]
    v_mfma_f32_16x16x32_bf16 v[108:111], v[48:51], v[28:31], v[108:111]
    v_perm_b32 v44, v199, v195, s91
    v_perm_b32 v48, v199, v195, s92
    v_perm_b32 v45, v207, v203, s91
    v_perm_b32 v49, v207, v203, s92
    v_perm_b32 v46, v215, v211, s91
    v_perm_b32 v50, v215, v211, s92
    v_perm_b32 v47, v223, v219, s91
    v_perm_b32 v51, v223, v219, s92
    v_mfma_f32_16x16x32_bf16 v[112:115], v[36:39], v[28:31], v[112:115]
    v_mfma_f32_16x16x32_bf16 v[116:119], v[40:43], v[28:31], v[116:119]
    v_mfma_f32_16x16x32_bf16 v[120:123], v[44:47], v[28:31], v[120:123]
    v_mfma_f32_16x16x32_bf16 v[124:127], v[48:51], v[28:31], v[124:127]
    s_cmp_ge_u32 s3, 2
    s_cbranch_scc1 L_nopk
    s_waitcnt lgkmcnt(0)
L_aw_a:
    ds_read_b32 v7, v3 offset:8
    s_waitcnt lgkmcnt(0)
    v_readfirstlane_b32 s83, v7
    s_nop 0
    s_cmp_lt_u32 s83, 4
    s_cbranch_scc1 L_aw_a
    ds_read_b128 v[68:71], v19 offset:5120
    ds_read_b128 v[72:75], v19 offset:5136
    ds_read_b128 v[208:211], v19 offset:5184
    ds_read_b128 v[212:215], v19 offset:5200
    ds_read_b128 v[52:55], v18 offset:8192
    ds_read_b128 v[56:59], v18 offset:12416
    ds_read_b128 v[60:63], v18 offset:16640
    ds_read_b128 v[64:67], v18 offset:20864
    ds_read_b128 v[192:195], v18 offset:9248
    ds_read_b128 v[196:199], v18 offset:13472
    ds_read_b128 v[200:203], v18 offset:17696
    ds_read_b128 v[204:207], v18 offset:21920
    s_add_u32 s83, s97, 0
    s_add_u32 s84, s83, 32768
    s_mov_b32 s6, 3
    s_mov_b32 s7, 3
    v_and_b32 v7, 1, v0
    v_cmp_ne_u32 vcc, 0, v7
    s_waitcnt lgkmcnt(8)
    v_max3_f32 v7, v68, v70, v72
    v_max_f32 v7, v7, v74
    v_mul_f32 v8, s93, v7
    v_mul_f32 v68, s93, v68
    v_mul_f32 v70, s93, v70
    v_mul_f32 v72, s93, v72
    v_mul_f32 v74, s93, v74
    v_sub_f32 v68, v68, v8
    v_sub_f32 v70, v70, v8
    v_sub_f32 v72, v72, v8
    v_sub_f32 v74, v74, v8
    v_exp_f32 v68, v68
    v_exp_f32 v70, v70
    v_exp_f32 v72, v72
    v_exp_f32 v74, v74
    v_max3_f32 v9, v208, v210, v212
    v_max_f32 v9, v9, v214
    v_mul_f32 v10, s93, v9
    v_mul_f32 v208, s93, v208
    v_mul_f32 v210, s93, v210
    v_mul_f32 v212, s93, v212
    v_mul_f32 v214, s93, v214
    v_sub_f32 v208, v208, v10
    v_sub_f32 v210, v210, v10
    v_sub_f32 v212, v212, v10
    v_sub_f32 v214, v214, v10
    v_exp_f32 v208, v208
    v_exp_f32 v210, v210
    v_exp_f32 v212, v212
    v_exp_f32 v214, v214
    s_waitcnt lgkmcnt(0)
    v_mul_f32 v52, v52, v68
    v_mul_f32 v53, v53, v68
    v_mul_f32 v54, v54, v68
    v_mul_f32 v55, v55, v68
    v_fmac_f32 v52, v56, v70
    v_fmac_f32 v53, v57, v70
    v_fmac_f32 v54, v58, v70
    v_fmac_f32 v55, v59, v70
    v_fmac_f32 v52, v60, v72
    v_fmac_f32 v53, v61, v72
    v_fmac_f32 v54, v62, v72
    v_fmac_f32 v55, v63, v72
    v_fmac_f32 v52, v64, v74
    v_fmac_f32 v53, v65, v74
    v_fmac_f32 v54, v66, v74
    v_fmac_f32 v55, v67, v74
    v_bfi_b32 v56, s95, v5, v52
    v_bfi_b32 v57, s95, v5, v53
    v_bfi_b32 v58, s95, v5, v54
    v_bfi_b32 v59, s95, v5, v55
    v_accvgpr_write_b32 a128, v56
    v_accvgpr_write_b32 a129, v57
    v_accvgpr_write_b32 a130, v58
    v_accvgpr_write_b32 a131, v59
    v_mul_f32 v192, v192, v208
    v_mul_f32 v193, v193, v208
    v_mul_f32 v194, v194, v208
    v_mul_f32 v195, v195, v208
    v_fmac_f32 v192, v196, v210
    v_fmac_f32 v193, v197, v210
    v_fmac_f32 v194, v198, v210
    v_fmac_f32 v195, v199, v210
    v_fmac_f32 v192, v200, v212
    v_fmac_f32 v193, v201, v212
    v_fmac_f32 v194, v202, v212
    v_fmac_f32 v195, v203, v212
    v_fmac_f32 v192, v204, v214
    v_fmac_f32 v193, v205, v214
    v_fmac_f32 v194, v206, v214
    v_fmac_f32 v195, v207, v214
    v_bfi_b32 v196, s95, v5, v192
    v_bfi_b32 v197, s95, v5, v193
    v_bfi_b32 v198, s95, v5, v194
    v_bfi_b32 v199, s95, v5, v195
    v_accvgpr_write_b32 a132, v196
    v_accvgpr_write_b32 a133, v197
    v_accvgpr_write_b32 a134, v198
    v_accvgpr_write_b32 a135, v199
    v_mul_f32 v8, v69, v68
    v_fmac_f32 v8, v71, v70
    v_fmac_f32 v8, v73, v72
    v_fmac_f32 v8, v75, v74
    v_mul_f32 v10, v209, v208
    v_fmac_f32 v10, v211, v210
    v_fmac_f32 v10, v213, v212
    v_fmac_f32 v10, v215, v214
    v_cndmask_b32 v60, v7, v9, vcc
    v_cndmask_b32 v61, v8, v10, vcc
    v_bfi_b32 v60, s95, v5, v60
    v_bfi_b32 v61, s95, v5, v61
    v_accvgpr_write_b32 a136, v60
    v_accvgpr_write_b32 a137, v61
L_nopk:
    s_nop 3
    s_add_u32 s83, s85, 135168
    buffer_load_dwordx4 a[48:51], v1, s[44:47], s83 offen offset:0 nt
    buffer_load_dwordx4 a[52:55], v1, s[44:47], s83 offen offset:1024 nt
    buffer_load_dwordx4 a[56:59], v1, s[44:47], s83 offen offset:2048 nt
    buffer_load_dwordx4 a[60:63], v1, s[44:47], s83 offen offset:3072 nt
    s_waitcnt vmcnt(32)
    ds_write_b128 v83, a[96:99] offset:0
    ds_write_b128 v83, a[100:103] offset:1088
    ds_write_b128 v83, a[104:107] offset:2176
    ds_write_b128 v83, a[108:111] offset:3264
    ds_write_b128 v83, a[112:115] offset:4352
    ds_write_b128 v83, a[116:119] offset:5440
    ds_write_b128 v83, a[120:123] offset:6528
    ds_write_b128 v83, a[124:127] offset:7616
    ds_read_b128 a[160:163], v84 offset:0
    ds_read_b128 a[176:179], v84 offset:4352
    ds_read_b128 a[164:167], v84 offset:64
    ds_read_b128 a[180:183], v84 offset:4416
    ds_read_b128 a[168:171], v84 offset:128
    ds_read_b128 a[184:187], v84 offset:4480
    ds_read_b128 a[172:175], v84 offset:192
    ds_read_b128 a[188:191], v84 offset:4544
    s_add_u32 s83, s85, 131072
    buffer_load_dwordx4 v[160:163], v1, s[48:51], s83 offen offset:0 nt
    buffer_load_dwordx4 v[164:167], v1, s[48:51], s83 offen offset:1024 nt
    buffer_load_dwordx4 v[168:171], v1, s[48:51], s83 offen offset:2048 nt
    buffer_load_dwordx4 v[172:175], v1, s[48:51], s83 offen offset:3072 nt
    s_waitcnt lgkmcnt(0)
    v_mfma_f32_16x16x32_bf16 v[20:23], a[160:163], a[144:147], 0
    v_mfma_f32_16x16x32_bf16 v[24:27], a[176:179], a[144:147], 0
    v_mfma_f32_16x16x32_bf16 v[20:23], a[164:167], a[148:151], v[20:23]
    v_mfma_f32_16x16x32_bf16 v[24:27], a[180:183], a[148:151], v[24:27]
    v_mfma_f32_16x16x32_bf16 v[20:23], a[168:171], a[152:155], v[20:23]
    v_mfma_f32_16x16x32_bf16 v[24:27], a[184:187], a[152:155], v[24:27]
    v_mfma_f32_16x16x32_bf16 v[20:23], a[172:175], a[156:159], v[20:23]
    v_mfma_f32_16x16x32_bf16 v[24:27], a[188:191], a[156:159], v[24:27]
    s_nop 6
    v_cvt_pk_bf16_f32 v32, v20, v21
    v_cvt_pk_bf16_f32 v33, v22, v23
    v_cvt_pk_bf16_f32 v34, v24, v25
    v_cvt_pk_bf16_f32 v35, v26, v27
    v_lshlrev_b32 v20, 16, v32
    v_and_b32 v21, s98, v32
    v_lshlrev_b32 v22, 16, v33
    v_and_b32 v23, s98, v33
    v_lshlrev_b32 v24, 16, v34
    v_and_b32 v25, s98, v34
    v_lshlrev_b32 v26, 16, v35
    v_and_b32 v27, s98, v35
    v_pk_mul_f32 v[20:21], v[20:21], s[4:5]
    v_pk_mul_f32 v[22:23], v[22:23], s[4:5]
    v_pk_mul_f32 v[24:25], v[24:25], s[4:5]
    v_pk_mul_f32 v[26:27], v[26:27], s[4:5]
    v_cvt_pk_bf16_f32 v32, v20, v21
    v_cvt_pk_bf16_f32 v33, v22, v23
    v_cvt_pk_bf16_f32 v34, v24, v25
    v_cvt_pk_bf16_f32 v35, v26, v27
    v_lshlrev_b32 v20, 16, v32
    v_and_b32 v21, s98, v32
    v_lshlrev_b32 v22, 16, v33
    v_and_b32 v23, s98, v33
    v_lshlrev_b32 v24, 16, v34
    v_and_b32 v25, s98, v34
    v_lshlrev_b32 v26, 16, v35
    v_and_b32 v27, s98, v35
    v_max3_f32 v7, v20, v21, v22
    v_max3_f32 v8, v23, v24, v25
    v_max3_f32 v7, v7, v26, v27
    v_max3_f32 v11, v7, v8, v11
    v_mov_b32 v8, v11
    s_nop 1
    v_permlane32_swap_b32 v11, v8
    v_max_f32 v11, v11, v8
    v_mov_b32 v8, v11
    s_nop 1
    v_permlane16_swap_b32 v11, v8
    v_max_f32 v11, v11, v8
    v_mov_b32 v9, v12
    v_mul_f32 v12, s93, v11
    v_sub_f32 v9, v9, v12
    v_exp_f32 v14, v9
    v_fma_f32 v20, v20, s93, -v12
    v_fma_f32 v21, v21, s93, -v12
    v_fma_f32 v22, v22, s93, -v12
    v_fma_f32 v23, v23, s93, -v12
    v_fma_f32 v24, v24, s93, -v12
    v_fma_f32 v25, v25, s93, -v12
    v_fma_f32 v26, v26, s93, -v12
    v_fma_f32 v27, v27, s93, -v12
    v_exp_f32 v20, v20
    v_exp_f32 v21, v21
    v_exp_f32 v22, v22
    v_exp_f32 v23, v23
    v_exp_f32 v24, v24
    v_exp_f32 v25, v25
    v_exp_f32 v26, v26
    v_exp_f32 v27, v27
    v_pk_mul_f32 v[96:97], v[96:97], v[14:15] op_sel_hi:[1,0]
    v_pk_mul_f32 v[98:99], v[98:99], v[14:15] op_sel_hi:[1,0]
    v_pk_mul_f32 v[100:101], v[100:101], v[14:15] op_sel_hi:[1,0]
    v_pk_mul_f32 v[102:103], v[102:103], v[14:15] op_sel_hi:[1,0]
    v_pk_mul_f32 v[104:105], v[104:105], v[14:15] op_sel_hi:[1,0]
    v_pk_mul_f32 v[106:107], v[106:107], v[14:15] op_sel_hi:[1,0]
    v_pk_mul_f32 v[108:109], v[108:109], v[14:15] op_sel_hi:[1,0]
    v_pk_mul_f32 v[110:111], v[110:111], v[14:15] op_sel_hi:[1,0]
    v_pk_mul_f32 v[112:113], v[112:113], v[14:15] op_sel_hi:[1,0]
    v_pk_mul_f32 v[114:115], v[114:115], v[14:15] op_sel_hi:[1,0]
    v_pk_mul_f32 v[116:117], v[116:117], v[14:15] op_sel_hi:[1,0]
    v_pk_mul_f32 v[118:119], v[118:119], v[14:15] op_sel_hi:[1,0]
    v_pk_mul_f32 v[120:121], v[120:121], v[14:15] op_sel_hi:[1,0]
    v_pk_mul_f32 v[122:123], v[122:123], v[14:15] op_sel_hi:[1,0]
    v_pk_mul_f32 v[124:125], v[124:125], v[14:15] op_sel_hi:[1,0]
    v_pk_mul_f32 v[126:127], v[126:127], v[14:15] op_sel_hi:[1,0]
    v_cvt_pk_bf16_f32 v28, v20, v21
    v_cvt_pk_bf16_f32 v29, v22, v23
    v_cvt_pk_bf16_f32 v30, v24, v25
    v_cvt_pk_bf16_f32 v31, v26, v27
    v_add_f32 v7, v20, v21
    v_add_f32 v8, v22, v23
    v_add_f32 v9, v24, v25
    v_add_f32 v10, v26, v27
    v_add_f32 v7, v7, v8
    v_add_f32 v9, v9, v10
    v_add_f32 v7, v7, v9
    v_fma_f32 v13, v13, v14, v7
    s_waitcnt vmcnt(28)
    v_perm_b32 v36, v228, v224, s91
    v_perm_b32 v40, v228, v224, s92
    v_perm_b32 v37, v236, v232, s91
    v_perm_b32 v41, v236, v232, s92
    v_perm_b32 v38, v244, v240, s91
    v_perm_b32 v42, v244, v240, s92
    v_perm_b32 v39, v252, v248, s91
    v_perm_b32 v43, v252, v248, s92
    v_perm_b32 v44, v229, v225, s91
    v_perm_b32 v48, v229, v225, s92
    v_perm_b32 v45, v237, v233, s91
    v_perm_b32 v49, v237, v233, s92
    v_perm_b32 v46, v245, v241, s91
    v_perm_b32 v50, v245, v241, s92
    v_perm_b32 v47, v253, v249, s91
    v_perm_b32 v51, v253, v249, s92
    v_mfma_f32_16x16x32_bf16 v[96:99], v[36:39], v[28:31], v[96:99]
    v_mfma_f32_16x16x32_bf16 v[100:103], v[40:43], v[28:31], v[100:103]
    v_perm_b32 v36, v230, v226, s91
    v_perm_b32 v40, v230, v226, s92
    v_perm_b32 v37, v238, v234, s91
    v_perm_b32 v41, v238, v234, s92
    v_perm_b32 v38, v246, v242, s91
    v_perm_b32 v42, v246, v242, s92
    v_perm_b32 v39, v254, v250, s91
    v_perm_b32 v43, v254, v250, s92
    v_mfma_f32_16x16x32_bf16 v[104:107], v[44:47], v[28:31], v[104:107]
    v_mfma_f32_16x16x32_bf16 v[108:111], v[48:51], v[28:31], v[108:111]
    v_perm_b32 v44, v231, v227, s91
    v_perm_b32 v48, v231, v227, s92
    v_perm_b32 v45, v239, v235, s91
    v_perm_b32 v49, v239, v235, s92
    v_perm_b32 v46, v247, v243, s91
    v_perm_b32 v50, v247, v243, s92
    v_perm_b32 v47, v255, v251, s91
    v_perm_b32 v51, v255, v251, s92
    v_mfma_f32_16x16x32_bf16 v[112:115], v[36:39], v[28:31], v[112:115]
    v_mfma_f32_16x16x32_bf16 v[116:119], v[40:43], v[28:31], v[116:119]
    v_mfma_f32_16x16x32_bf16 v[120:123], v[44:47], v[28:31], v[120:123]
    v_mfma_f32_16x16x32_bf16 v[124:127], v[48:51], v[28:31], v[124:127]
    s_add_u32 s83, s85, 135168
    buffer_load_dwordx4 v[176:179], v1, s[48:51], s83 offen offset:0 nt
    buffer_load_dwordx4 v[180:183], v1, s[48:51], s83 offen offset:1024 nt
    buffer_load_dwordx4 v[184:187], v1, s[48:51], s83 offen offset:2048 nt
    buffer_load_dwordx4 v[188:191], v1, s[48:51], s83 offen offset:3072 nt
    s_waitcnt vmcnt(24)
    ds_write_b128 v83, a[0:3] offset:0
    ds_write_b128 v83, a[4:7] offset:1088
    ds_write_b128 v83, a[8:11] offset:2176
    ds_write_b128 v83, a[12:15] offset:3264
    ds_write_b128 v83, a[16:19] offset:4352
    ds_write_b128 v83, a[20:23] offset:5440
    ds_write_b128 v83, a[24:27] offset:6528
    ds_write_b128 v83, a[28:31] offset:7616
    ds_read_b128 a[160:163], v84 offset:0
    ds_read_b128 a[176:179], v84 offset:4352
    ds_read_b128 a[164:167], v84 offset:64
    ds_read_b128 a[180:183], v84 offset:4416
    ds_read_b128 a[168:171], v84 offset:128
    ds_read_b128 a[184:187], v84 offset:4480
    ds_read_b128 a[172:175], v84 offset:192
    ds_read_b128 a[188:191], v84 offset:4544
    s_add_u32 s83, s85, 163840
    buffer_load_dwordx4 a[64:67], v1, s[44:47], s83 offen offset:0 nt
    buffer_load_dwordx4 a[68:71], v1, s[44:47], s83 offen offset:1024 nt
    buffer_load_dwordx4 a[72:75], v1, s[44:47], s83 offen offset:2048 nt
    buffer_load_dwordx4 a[76:79], v1, s[44:47], s83 offen offset:3072 nt
    s_waitcnt lgkmcnt(0)
    v_mfma_f32_16x16x32_bf16 v[20:23], a[160:163], a[144:147], 0
    v_mfma_f32_16x16x32_bf16 v[24:27], a[176:179], a[144:147], 0
    v_mfma_f32_16x16x32_bf16 v[20:23], a[164:167], a[148:151], v[20:23]
    v_mfma_f32_16x16x32_bf16 v[24:27], a[180:183], a[148:151], v[24:27]
    v_mfma_f32_16x16x32_bf16 v[20:23], a[168:171], a[152:155], v[20:23]
    v_mfma_f32_16x16x32_bf16 v[24:27], a[184:187], a[152:155], v[24:27]
    v_mfma_f32_16x16x32_bf16 v[20:23], a[172:175], a[156:159], v[20:23]
    v_mfma_f32_16x16x32_bf16 v[24:27], a[188:191], a[156:159], v[24:27]
    s_nop 6
    v_cvt_pk_bf16_f32 v32, v20, v21
    v_cvt_pk_bf16_f32 v33, v22, v23
    v_cvt_pk_bf16_f32 v34, v24, v25
    v_cvt_pk_bf16_f32 v35, v26, v27
    v_lshlrev_b32 v20, 16, v32
    v_and_b32 v21, s98, v32
    v_lshlrev_b32 v22, 16, v33
    v_and_b32 v23, s98, v33
    v_lshlrev_b32 v24, 16, v34
    v_and_b32 v25, s98, v34
    v_lshlrev_b32 v26, 16, v35
    v_and_b32 v27, s98, v35
    v_pk_mul_f32 v[20:21], v[20:21], s[4:5]
    v_pk_mul_f32 v[22:23], v[22:23], s[4:5]
    v_pk_mul_f32 v[24:25], v[24:25], s[4:5]
    v_pk_mul_f32 v[26:27], v[26:27], s[4:5]
    v_cvt_pk_bf16_f32 v32, v20, v21
    v_cvt_pk_bf16_f32 v33, v22, v23
    v_cvt_pk_bf16_f32 v34, v24, v25
    v_cvt_pk_bf16_f32 v35, v26, v27
    v_lshlrev_b32 v20, 16, v32
    v_and_b32 v21, s98, v32
    v_lshlrev_b32 v22, 16, v33
    v_and_b32 v23, s98, v33
    v_lshlrev_b32 v24, 16, v34
    v_and_b32 v25, s98, v34
    v_lshlrev_b32 v26, 16, v35
    v_and_b32 v27, s98, v35
    v_max3_f32 v7, v20, v21, v22
    v_max3_f32 v8, v23, v24, v25
    v_max3_f32 v7, v7, v26, v27
    v_max3_f32 v11, v7, v8, v11
    v_mov_b32 v8, v11
    s_nop 1
    v_permlane32_swap_b32 v11, v8
    v_max_f32 v11, v11, v8
    v_mov_b32 v8, v11
    s_nop 1
    v_permlane16_swap_b32 v11, v8
    v_max_f32 v11, v11, v8
    v_mov_b32 v9, v12
    v_mul_f32 v12, s93, v11
    v_sub_f32 v9, v9, v12
    v_exp_f32 v14, v9
    v_fma_f32 v20, v20, s93, -v12
    v_fma_f32 v21, v21, s93, -v12
    v_fma_f32 v22, v22, s93, -v12
    v_fma_f32 v23, v23, s93, -v12
    v_fma_f32 v24, v24, s93, -v12
    v_fma_f32 v25, v25, s93, -v12
    v_fma_f32 v26, v26, s93, -v12
    v_fma_f32 v27, v27, s93, -v12
    v_exp_f32 v20, v20
    v_exp_f32 v21, v21
    v_exp_f32 v22, v22
    v_exp_f32 v23, v23
    v_exp_f32 v24, v24
    v_exp_f32 v25, v25
    v_exp_f32 v26, v26
    v_exp_f32 v27, v27
    v_pk_mul_f32 v[96:97], v[96:97], v[14:15] op_sel_hi:[1,0]
    v_pk_mul_f32 v[98:99], v[98:99], v[14:15] op_sel_hi:[1,0]
    v_pk_mul_f32 v[100:101], v[100:101], v[14:15] op_sel_hi:[1,0]
    v_pk_mul_f32 v[102:103], v[102:103], v[14:15] op_sel_hi:[1,0]
    v_pk_mul_f32 v[104:105], v[104:105], v[14:15] op_sel_hi:[1,0]
    v_pk_mul_f32 v[106:107], v[106:107], v[14:15] op_sel_hi:[1,0]
    v_pk_mul_f32 v[108:109], v[108:109], v[14:15] op_sel_hi:[1,0]
    v_pk_mul_f32 v[110:111], v[110:111], v[14:15] op_sel_hi:[1,0]
    v_pk_mul_f32 v[112:113], v[112:113], v[14:15] op_sel_hi:[1,0]
    v_pk_mul_f32 v[114:115], v[114:115], v[14:15] op_sel_hi:[1,0]
    v_pk_mul_f32 v[116:117], v[116:117], v[14:15] op_sel_hi:[1,0]
    v_pk_mul_f32 v[118:119], v[118:119], v[14:15] op_sel_hi:[1,0]
    v_pk_mul_f32 v[120:121], v[120:121], v[14:15] op_sel_hi:[1,0]
    v_pk_mul_f32 v[122:123], v[122:123], v[14:15] op_sel_hi:[1,0]
    v_pk_mul_f32 v[124:125], v[124:125], v[14:15] op_sel_hi:[1,0]
    v_pk_mul_f32 v[126:127], v[126:127], v[14:15] op_sel_hi:[1,0]
    v_cvt_pk_bf16_f32 v28, v20, v21
    v_cvt_pk_bf16_f32 v29, v22, v23
    v_cvt_pk_bf16_f32 v30, v24, v25
    v_cvt_pk_bf16_f32 v31, v26, v27
    v_add_f32 v7, v20, v21
    v_add_f32 v8, v22, v23
    v_add_f32 v9, v24, v25
    v_add_f32 v10, v26, v27
    v_add_f32 v7, v7, v8
    v_add_f32 v9, v9, v10
    v_add_f32 v7, v7, v9
    v_fma_f32 v13, v13, v14, v7
    s_waitcnt vmcnt(20)
    v_perm_b32 v36, v132, v128, s91
    v_perm_b32 v40, v132, v128, s92
    v_perm_b32 v37, v140, v136, s91
    v_perm_b32 v41, v140, v136, s92
    v_perm_b32 v38, v148, v144, s91
    v_perm_b32 v42, v148, v144, s92
    v_perm_b32 v39, v156, v152, s91
    v_perm_b32 v43, v156, v152, s92
    v_perm_b32 v44, v133, v129, s91
    v_perm_b32 v48, v133, v129, s92
    v_perm_b32 v45, v141, v137, s91
    v_perm_b32 v49, v141, v137, s92
    v_perm_b32 v46, v149, v145, s91
    v_perm_b32 v50, v149, v145, s92
    v_perm_b32 v47, v157, v153, s91
    v_perm_b32 v51, v157, v153, s92
    v_mfma_f32_16x16x32_bf16 v[96:99], v[36:39], v[28:31], v[96:99]
    v_mfma_f32_16x16x32_bf16 v[100:103], v[40:43], v[28:31], v[100:103]
    v_perm_b32 v36, v134, v130, s91
    v_perm_b32 v40, v134, v130, s92
    v_perm_b32 v37, v142, v138, s91
    v_perm_b32 v41, v142, v138, s92
    v_perm_b32 v38, v150, v146, s91
    v_perm_b32 v42, v150, v146, s92
    v_perm_b32 v39, v158, v154, s91
    v_perm_b32 v43, v158, v154, s92
    v_mfma_f32_16x16x32_bf16 v[104:107], v[44:47], v[28:31], v[104:107]
    v_mfma_f32_16x16x32_bf16 v[108:111], v[48:51], v[28:31], v[108:111]
    v_perm_b32 v44, v135, v131, s91
    v_perm_b32 v48, v135, v131, s92
    v_perm_b32 v45, v143, v139, s91
    v_perm_b32 v49, v143, v139, s92
    v_perm_b32 v46, v151, v147, s91
    v_perm_b32 v50, v151, v147, s92
    v_perm_b32 v47, v159, v155, s91
    v_perm_b32 v51, v159, v155, s92
    v_mfma_f32_16x16x32_bf16 v[112:115], v[36:39], v[28:31], v[112:115]
    v_mfma_f32_16x16x32_bf16 v[116:119], v[40:43], v[28:31], v[116:119]
    v_mfma_f32_16x16x32_bf16 v[120:123], v[44:47], v[28:31], v[120:123]
    v_mfma_f32_16x16x32_bf16 v[124:127], v[48:51], v[28:31], v[124:127]
    s_add_u32 s83, s85, 163840
    buffer_load_dwordx4 v[128:131], v1, s[48:51], s83 offen offset:0 nt
    buffer_load_dwordx4 v[132:135], v1, s[48:51], s83 offen offset:1024 nt
    buffer_load_dwordx4 v[136:139], v1, s[48:51], s83 offen offset:2048 nt
    buffer_load_dwordx4 v[140:143], v1, s[48:51], s83 offen offset:3072 nt
    s_waitcnt vmcnt(16)
    ds_write_b128 v83, a[32:35] offset:0
    ds_write_b128 v83, a[36:39] offset:1088
    ds_write_b128 v83, a[40:43] offset:2176
    ds_write_b128 v83, a[44:47] offset:3264
    ds_write_b128 v83, a[48:51] offset:4352
    ds_write_b128 v83, a[52:55] offset:5440
    ds_write_b128 v83, a[56:59] offset:6528
    ds_write_b128 v83, a[60:63] offset:7616
    ds_read_b128 a[160:163], v84 offset:0
    ds_read_b128 a[176:179], v84 offset:4352
    ds_read_b128 a[164:167], v84 offset:64
    ds_read_b128 a[180:183], v84 offset:4416
    ds_read_b128 a[168:171], v84 offset:128
    ds_read_b128 a[184:187], v84 offset:4480
    ds_read_b128 a[172:175], v84 offset:192
    ds_read_b128 a[188:191], v84 offset:4544
    s_add_u32 s83, s85, 167936
    buffer_load_dwordx4 a[80:83], v1, s[44:47], s83 offen offset:0 nt
    buffer_load_dwordx4 a[84:87], v1, s[44:47], s83 offen offset:1024 nt
    buffer_load_dwordx4 a[88:91], v1, s[44:47], s83 offen offset:2048 nt
    buffer_load_dwordx4 a[92:95], v1, s[44:47], s83 offen offset:3072 nt
    s_waitcnt lgkmcnt(0)
    v_mfma_f32_16x16x32_bf16 v[20:23], a[160:163], a[144:147], 0
    v_mfma_f32_16x16x32_bf16 v[24:27], a[176:179], a[144:147], 0
    v_mfma_f32_16x16x32_bf16 v[20:23], a[164:167], a[148:151], v[20:23]
    v_mfma_f32_16x16x32_bf16 v[24:27], a[180:183], a[148:151], v[24:27]
    v_mfma_f32_16x16x32_bf16 v[20:23], a[168:171], a[152:155], v[20:23]
    v_mfma_f32_16x16x32_bf16 v[24:27], a[184:187], a[152:155], v[24:27]
    v_mfma_f32_16x16x32_bf16 v[20:23], a[172:175], a[156:159], v[20:23]
    v_mfma_f32_16x16x32_bf16 v[24:27], a[188:191], a[156:159], v[24:27]
    s_nop 6
    v_cvt_pk_bf16_f32 v32, v20, v21
    v_cvt_pk_bf16_f32 v33, v22, v23
    v_cvt_pk_bf16_f32 v34, v24, v25
    v_cvt_pk_bf16_f32 v35, v26, v27
    v_lshlrev_b32 v20, 16, v32
    v_and_b32 v21, s98, v32
    v_lshlrev_b32 v22, 16, v33
    v_and_b32 v23, s98, v33
    v_lshlrev_b32 v24, 16, v34
    v_and_b32 v25, s98, v34
    v_lshlrev_b32 v26, 16, v35
    v_and_b32 v27, s98, v35
    v_pk_mul_f32 v[20:21], v[20:21], s[4:5]
    v_pk_mul_f32 v[22:23], v[22:23], s[4:5]
    v_pk_mul_f32 v[24:25], v[24:25], s[4:5]
    v_pk_mul_f32 v[26:27], v[26:27], s[4:5]
    v_cvt_pk_bf16_f32 v32, v20, v21
    v_cvt_pk_bf16_f32 v33, v22, v23
    v_cvt_pk_bf16_f32 v34, v24, v25
    v_cvt_pk_bf16_f32 v35, v26, v27
    v_lshlrev_b32 v20, 16, v32
    v_and_b32 v21, s98, v32
    v_lshlrev_b32 v22, 16, v33
    v_and_b32 v23, s98, v33
    v_lshlrev_b32 v24, 16, v34
    v_and_b32 v25, s98, v34
    v_lshlrev_b32 v26, 16, v35
    v_and_b32 v27, s98, v35
    v_max3_f32 v7, v20, v21, v22
    v_max3_f32 v8, v23, v24, v25
    v_max3_f32 v7, v7, v26, v27
    v_max3_f32 v11, v7, v8, v11
    v_mov_b32 v8, v11
    s_nop 1
    v_permlane32_swap_b32 v11, v8
    v_max_f32 v11, v11, v8
    v_mov_b32 v8, v11
    s_nop 1
    v_permlane16_swap_b32 v11, v8
    v_max_f32 v11, v11, v8
    v_mov_b32 v9, v12
    v_mul_f32 v12, s93, v11
    v_sub_f32 v9, v9, v12
    v_exp_f32 v14, v9
    v_fma_f32 v20, v20, s93, -v12
    v_fma_f32 v21, v21, s93, -v12
    v_fma_f32 v22, v22, s93, -v12
    v_fma_f32 v23, v23, s93, -v12
    v_fma_f32 v24, v24, s93, -v12
    v_fma_f32 v25, v25, s93, -v12
    v_fma_f32 v26, v26, s93, -v12
    v_fma_f32 v27, v27, s93, -v12
    v_exp_f32 v20, v20
    v_exp_f32 v21, v21
    v_exp_f32 v22, v22
    v_exp_f32 v23, v23
    v_exp_f32 v24, v24
    v_exp_f32 v25, v25
    v_exp_f32 v26, v26
    v_exp_f32 v27, v27
    v_pk_mul_f32 v[96:97], v[96:97], v[14:15] op_sel_hi:[1,0]
    v_pk_mul_f32 v[98:99], v[98:99], v[14:15] op_sel_hi:[1,0]
    v_pk_mul_f32 v[100:101], v[100:101], v[14:15] op_sel_hi:[1,0]
    v_pk_mul_f32 v[102:103], v[102:103], v[14:15] op_sel_hi:[1,0]
    v_pk_mul_f32 v[104:105], v[104:105], v[14:15] op_sel_hi:[1,0]
    v_pk_mul_f32 v[106:107], v[106:107], v[14:15] op_sel_hi:[1,0]
    v_pk_mul_f32 v[108:109], v[108:109], v[14:15] op_sel_hi:[1,0]
    v_pk_mul_f32 v[110:111], v[110:111], v[14:15] op_sel_hi:[1,0]
    v_pk_mul_f32 v[112:113], v[112:113], v[14:15] op_sel_hi:[1,0]
    v_pk_mul_f32 v[114:115], v[114:115], v[14:15] op_sel_hi:[1,0]
    v_pk_mul_f32 v[116:117], v[116:117], v[14:15] op_sel_hi:[1,0]
    v_pk_mul_f32 v[118:119], v[118:119], v[14:15] op_sel_hi:[1,0]
    v_pk_mul_f32 v[120:121], v[120:121], v[14:15] op_sel_hi:[1,0]
    v_pk_mul_f32 v[122:123], v[122:123], v[14:15] op_sel_hi:[1,0]
    v_pk_mul_f32 v[124:125], v[124:125], v[14:15] op_sel_hi:[1,0]
    v_pk_mul_f32 v[126:127], v[126:127], v[14:15] op_sel_hi:[1,0]
    v_cvt_pk_bf16_f32 v28, v20, v21
    v_cvt_pk_bf16_f32 v29, v22, v23
    v_cvt_pk_bf16_f32 v30, v24, v25
    v_cvt_pk_bf16_f32 v31, v26, v27
    v_add_f32 v7, v20, v21
    v_add_f32 v8, v22, v23
    v_add_f32 v9, v24, v25
    v_add_f32 v10, v26, v27
    v_add_f32 v7, v7, v8
    v_add_f32 v9, v9, v10
    v_add_f32 v7, v7, v9
    v_fma_f32 v13, v13, v14, v7
    s_add_u32 s83, s85, 167936
    buffer_load_dwordx4 v[144:147], v1, s[48:51], s83 offen offset:0 nt
    buffer_load_dwordx4 v[148:151], v1, s[48:51], s83 offen offset:1024 nt
    buffer_load_dwordx4 v[152:155], v1, s[48:51], s83 offen offset:2048 nt
    buffer_load_dwordx4 v[156:159], v1, s[48:51], s83 offen offset:3072 nt
    s_waitcnt vmcnt(16)
    v_perm_b32 v36, v164, v160, s91
    v_perm_b32 v40, v164, v160, s92
    v_perm_b32 v37, v172, v168, s91
    v_perm_b32 v41, v172, v168, s92
    v_perm_b32 v38, v180, v176, s91
    v_perm_b32 v42, v180, v176, s92
    v_perm_b32 v39, v188, v184, s91
    v_perm_b32 v43, v188, v184, s92
    v_perm_b32 v44, v165, v161, s91
    v_perm_b32 v48, v165, v161, s92
    v_perm_b32 v45, v173, v169, s91
    v_perm_b32 v49, v173, v169, s92
    v_perm_b32 v46, v181, v177, s91
    v_perm_b32 v50, v181, v177, s92
    v_perm_b32 v47, v189, v185, s91
    v_perm_b32 v51, v189, v185, s92
    v_mfma_f32_16x16x32_bf16 v[96:99], v[36:39], v[28:31], v[96:99]
    v_mfma_f32_16x16x32_bf16 v[100:103], v[40:43], v[28:31], v[100:103]
    v_perm_b32 v36, v166, v162, s91
    v_perm_b32 v40, v166, v162, s92
    v_perm_b32 v37, v174, v170, s91
    v_perm_b32 v41, v174, v170, s92
    v_perm_b32 v38, v182, v178, s91
    v_perm_b32 v42, v182, v178, s92
    v_perm_b32 v39, v190, v186, s91
    v_perm_b32 v43, v190, v186, s92
    v_mfma_f32_16x16x32_bf16 v[104:107], v[44:47], v[28:31], v[104:107]
    v_mfma_f32_16x16x32_bf16 v[108:111], v[48:51], v[28:31], v[108:111]
    v_perm_b32 v44, v167, v163, s91
    v_perm_b32 v48, v167, v163, s92
    v_perm_b32 v45, v175, v171, s91
    v_perm_b32 v49, v175, v171, s92
    v_perm_b32 v46, v183, v179, s91
    v_perm_b32 v50, v183, v179, s92
    v_perm_b32 v47, v191, v187, s91
    v_perm_b32 v51, v191, v187, s92
    v_mfma_f32_16x16x32_bf16 v[112:115], v[36:39], v[28:31], v[112:115]
    v_mfma_f32_16x16x32_bf16 v[116:119], v[40:43], v[28:31], v[116:119]
    v_mfma_f32_16x16x32_bf16 v[120:123], v[44:47], v[28:31], v[120:123]
    v_mfma_f32_16x16x32_bf16 v[124:127], v[48:51], v[28:31], v[124:127]
    s_mov_b32 s35, 1
    s_atomic_add s35, s[64:65], s90 glc
    s_waitcnt lgkmcnt(0)
    s_mov_b32 s83, s35
    s_cmp_ge_u32 s83, s55
    s_cbranch_scc1 L_drain0
    s_and_b32 s84, s83, 31
    s_lshl_b32 s53, s84, 18
    s_add_u32 s53, s53, s52
    s_lshr_b32 s84, s83, 6
    s_lshl_b32 s84, s84, 15
    s_add_u32 s53, s53, s84
    s_bfe_u32 s84, s83, 0x10005
    s_lshl_b32 s84, s84, 12
    s_add_u32 s53, s53, s84
L_it0:
    s_nop 1
    s_add_u32 s83, s53, 0
    buffer_load_dwordx4 a[96:99], v1, s[44:47], s83 offen offset:0 nt
    buffer_load_dwordx4 a[100:103], v1, s[44:47], s83 offen offset:1024 nt
    buffer_load_dwordx4 a[104:107], v1, s[44:47], s83 offen offset:2048 nt
    buffer_load_dwordx4 a[108:111], v1, s[44:47], s83 offen offset:3072 nt
    s_add_u32 s83, s53, 0
    buffer_load_dwordx4 v[160:163], v1, s[48:51], s83 offen offset:0 nt
    buffer_load_dwordx4 v[164:167], v1, s[48:51], s83 offen offset:1024 nt
    buffer_load_dwordx4 v[168:171], v1, s[48:51], s83 offen offset:2048 nt
    buffer_load_dwordx4 v[172:175], v1, s[48:51], s83 offen offset:3072 nt
    s_waitcnt vmcnt(20)
    ds_write_b128 v83, a[64:67] offset:0
    ds_write_b128 v83, a[68:71] offset:1088
    ds_write_b128 v83, a[72:75] offset:2176
    ds_write_b128 v83, a[76:79] offset:3264
    ds_read_b128 a[160:163], v84 offset:0
    ds_read_b128 a[164:167], v84 offset:64
    ds_read_b128 a[168:171], v84 offset:128
    ds_read_b128 a[172:175], v84 offset:192
    s_waitcnt lgkmcnt(0)
    v_mfma_f32_16x16x32_bf16 v[20:23], a[160:163], a[144:147], 0
    v_mfma_f32_16x16x32_bf16 v[20:23], a[164:167], a[148:151], v[20:23]
    v_mfma_f32_16x16x32_bf16 v[20:23], a[168:171], a[152:155], v[20:23]
    v_mfma_f32_16x16x32_bf16 v[20:23], a[172:175], a[156:159], v[20:23]
    s_mov_b32 s35, 1
    s_atomic_add s35, s[64:65], s90 glc
    s_nop 5
    v_cvt_pk_bf16_f32 v32, v20, v21
    v_cvt_pk_bf16_f32 v33, v22, v23
    v_lshlrev_b32 v20, 16, v32
    v_and_b32 v21, s98, v32
    v_lshlrev_b32 v22, 16, v33
    v_and_b32 v23, s98, v33
    v_pk_mul_f32 v[20:21], v[20:21], s[4:5]
    v_pk_mul_f32 v[22:23], v[22:23], s[4:5]
    v_cvt_pk_bf16_f32 v32, v20, v21
    v_cvt_pk_bf16_f32 v33, v22, v23
    v_lshlrev_b32 v20, 16, v32
    v_and_b32 v21, s98, v32
    v_lshlrev_b32 v22, 16, v33
    v_and_b32 v23, s98, v33
    v_max3_f32 v7, v20, v21, v22
    v_max3_f32 v11, v7, v23, v11
    v_mov_b32 v8, v11
    s_nop 1
    v_permlane32_swap_b32 v11, v8
    v_max_f32 v11, v11, v8
    v_mov_b32 v8, v11
    s_nop 1
    v_permlane16_swap_b32 v11, v8
    v_max_f32 v11, v11, v8
    v_mov_b32 v9, v12
    v_mul_f32 v12, s93, v11
    v_sub_f32 v9, v9, v12
    v_exp_f32 v14, v9
    v_fma_f32 v20, v20, s93, -v12
    v_fma_f32 v21, v21, s93, -v12
    v_fma_f32 v22, v22, s93, -v12
    v_fma_f32 v23, v23, s93, -v12
    v_exp_f32 v20, v20
    v_exp_f32 v21, v21
    v_exp_f32 v22, v22
    v_exp_f32 v23, v23
    v_pk_mul_f32 v[96:97], v[96:97], v[14:15] op_sel_hi:[1,0]
    v_pk_mul_f32 v[98:99], v[98:99], v[14:15] op_sel_hi:[1,0]
    v_pk_mul_f32 v[100:101], v[100:101], v[14:15] op_sel_hi:[1,0]
    v_pk_mul_f32 v[102:103], v[102:103], v[14:15] op_sel_hi:[1,0]
    v_pk_mul_f32 v[104:105], v[104:105], v[14:15] op_sel_hi:[1,0]
    v_pk_mul_f32 v[106:107], v[106:107], v[14:15] op_sel_hi:[1,0]
    v_pk_mul_f32 v[108:109], v[108:109], v[14:15] op_sel_hi:[1,0]
    v_pk_mul_f32 v[110:111], v[110:111], v[14:15] op_sel_hi:[1,0]
    v_pk_mul_f32 v[112:113], v[112:113], v[14:15] op_sel_hi:[1,0]
    v_pk_mul_f32 v[114:115], v[114:115], v[14:15] op_sel_hi:[1,0]
    v_pk_mul_f32 v[116:117], v[116:117], v[14:15] op_sel_hi:[1,0]
    v_pk_mul_f32 v[118:119], v[118:119], v[14:15] op_sel_hi:[1,0]
    v_pk_mul_f32 v[120:121], v[120:121], v[14:15] op_sel_hi:[1,0]
    v_pk_mul_f32 v[122:123], v[122:123], v[14:15] op_sel_hi:[1,0]
    v_pk_mul_f32 v[124:125], v[124:125], v[14:15] op_sel_hi:[1,0]
    v_pk_mul_f32 v[126:127], v[126:127], v[14:15] op_sel_hi:[1,0]
    v_cvt_pk_bf16_f32 v28, v20, v21
    v_cvt_pk_bf16_f32 v29, v22, v23
    v_add_f32 v7, v20, v21
    v_add_f32 v8, v22, v23
    v_add_f32 v7, v7, v8
    v_fma_f32 v13, v13, v14, v7
    s_waitcnt vmcnt(16)
    v_perm_b32 v36, v132, v128, s91
    v_perm_b32 v38, v132, v128, s92
    v_perm_b32 v37, v140, v136, s91
    v_perm_b32 v39, v140, v136, s92
    v_perm_b32 v40, v133, v129, s91
    v_perm_b32 v42, v133, v129, s92
    v_perm_b32 v41, v141, v137, s91
    v_perm_b32 v43, v141, v137, s92
    v_mfma_f32_16x16x16_bf16 v[96:99], v[36:37], v[28:29], v[96:99]
    v_mfma_f32_16x16x16_bf16 v[100:103], v[38:39], v[28:29], v[100:103]
    v_perm_b32 v44, v134, v130, s91
    v_perm_b32 v46, v134, v130, s92
    v_perm_b32 v45, v142, v138, s91
    v_perm_b32 v47, v142, v138, s92
    v_mfma_f32_16x16x16_bf16 v[104:107], v[40:41], v[28:29], v[104:107]
    v_mfma_f32_16x16x16_bf16 v[108:111], v[42:43], v[28:29], v[108:111]
    v_perm_b32 v48, v135, v131, s91
    v_perm_b32 v50, v135, v131, s92
    v_perm_b32 v49, v143, v139, s91
    v_perm_b32 v51, v143, v139, s92
    v_mfma_f32_16x16x16_bf16 v[112:115], v[44:45], v[28:29], v[112:115]
    v_mfma_f32_16x16x16_bf16 v[116:119], v[46:47], v[28:29], v[116:119]
    v_mfma_f32_16x16x16_bf16 v[120:123], v[48:49], v[28:29], v[120:123]
    v_mfma_f32_16x16x16_bf16 v[124:127], v[50:51], v[28:29], v[124:127]
    s_waitcnt lgkmcnt(0)
    s_mov_b32 s83, s35
    s_cmp_ge_u32 s83, s55
    s_cbranch_scc1 L_drain1
    s_and_b32 s84, s83, 31
    s_lshl_b32 s53, s84, 18
    s_add_u32 s53, s53, s52
    s_lshr_b32 s84, s83, 6
    s_lshl_b32 s84, s84, 15
    s_add_u32 s53, s53, s84
    s_bfe_u32 s84, s83, 0x10005
    s_lshl_b32 s84, s84, 12
    s_add_u32 s53, s53, s84
L_it1:
    s_nop 1
    s_add_u32 s83, s53, 0
    buffer_load_dwordx4 a[64:67], v1, s[44:47], s83 offen offset:0 nt
    buffer_load_dwordx4 a[68:71], v1, s[44:47], s83 offen offset:1024 nt
    buffer_load_dwordx4 a[72:75], v1, s[44:47], s83 offen offset:2048 nt
    buffer_load_dwordx4 a[76:79], v1, s[44:47], s83 offen offset:3072 nt
    s_add_u32 s83, s53, 0
    buffer_load_dwordx4 v[128:131], v1, s[48:51], s83 offen offset:0 nt
    buffer_load_dwordx4 v[132:135], v1, s[48:51], s83 offen offset:1024 nt
    buffer_load_dwordx4 v[136:139], v1, s[48:51], s83 offen offset:2048 nt
    buffer_load_dwordx4 v[140:143], v1, s[48:51], s83 offen offset:3072 nt
    s_waitcnt vmcnt(20)
    ds_write_b128 v83, a[80:83] offset:0
    ds_write_b128 v83, a[84:87] offset:1088
    ds_write_b128 v83, a[88:91] offset:2176
    ds_write_b128 v83, a[92:95] offset:3264
    ds_read_b128 a[160:163], v84 offset:0
    ds_read_b128 a[164:167], v84 offset:64
    ds_read_b128 a[168:171], v84 offset:128
    ds_read_b128 a[172:175], v84 offset:192
    s_waitcnt lgkmcnt(0)
    v_mfma_f32_16x16x32_bf16 v[20:23], a[160:163], a[144:147], 0
    v_mfma_f32_16x16x32_bf16 v[20:23], a[164:167], a[148:151], v[20:23]
    v_mfma_f32_16x16x32_bf16 v[20:23], a[168:171], a[152:155], v[20:23]
    v_mfma_f32_16x16x32_bf16 v[20:23], a[172:175], a[156:159], v[20:23]
    s_mov_b32 s35, 1
    s_atomic_add s35, s[64:65], s90 glc
    s_nop 5
    v_cvt_pk_bf16_f32 v32, v20, v21
    v_cvt_pk_bf16_f32 v33, v22, v23
    v_lshlrev_b32 v20, 16, v32
    v_and_b32 v21, s98, v32
    v_lshlrev_b32 v22, 16, v33
    v_and_b32 v23, s98, v33
    v_pk_mul_f32 v[20:21], v[20:21], s[4:5]
    v_pk_mul_f32 v[22:23], v[22:23], s[4:5]
    v_cvt_pk_bf16_f32 v32, v20, v21
    v_cvt_pk_bf16_f32 v33, v22, v23
    v_lshlrev_b32 v20, 16, v32
    v_and_b32 v21, s98, v32
    v_lshlrev_b32 v22, 16, v33
    v_and_b32 v23, s98, v33
    v_max3_f32 v7, v20, v21, v22
    v_max3_f32 v11, v7, v23, v11
    v_mov_b32 v8, v11
    s_nop 1
    v_permlane32_swap_b32 v11, v8
    v_max_f32 v11, v11, v8
    v_mov_b32 v8, v11
    s_nop 1
    v_permlane16_swap_b32 v11, v8
    v_max_f32 v11, v11, v8
    v_mov_b32 v9, v12
    v_mul_f32 v12, s93, v11
    v_sub_f32 v9, v9, v12
    v_exp_f32 v14, v9
    v_fma_f32 v20, v20, s93, -v12
    v_fma_f32 v21, v21, s93, -v12
    v_fma_f32 v22, v22, s93, -v12
    v_fma_f32 v23, v23, s93, -v12
    v_exp_f32 v20, v20
    v_exp_f32 v21, v21
    v_exp_f32 v22, v22
    v_exp_f32 v23, v23
    v_pk_mul_f32 v[96:97], v[96:97], v[14:15] op_sel_hi:[1,0]
    v_pk_mul_f32 v[98:99], v[98:99], v[14:15] op_sel_hi:[1,0]
    v_pk_mul_f32 v[100:101], v[100:101], v[14:15] op_sel_hi:[1,0]
    v_pk_mul_f32 v[102:103], v[102:103], v[14:15] op_sel_hi:[1,0]
    v_pk_mul_f32 v[104:105], v[104:105], v[14:15] op_sel_hi:[1,0]
    v_pk_mul_f32 v[106:107], v[106:107], v[14:15] op_sel_hi:[1,0]
    v_pk_mul_f32 v[108:109], v[108:109], v[14:15] op_sel_hi:[1,0]
    v_pk_mul_f32 v[110:111], v[110:111], v[14:15] op_sel_hi:[1,0]
    v_pk_mul_f32 v[112:113], v[112:113], v[14:15] op_sel_hi:[1,0]
    v_pk_mul_f32 v[114:115], v[114:115], v[14:15] op_sel_hi:[1,0]
    v_pk_mul_f32 v[116:117], v[116:117], v[14:15] op_sel_hi:[1,0]
    v_pk_mul_f32 v[118:119], v[118:119], v[14:15] op_sel_hi:[1,0]
    v_pk_mul_f32 v[120:121], v[120:121], v[14:15] op_sel_hi:[1,0]
    v_pk_mul_f32 v[122:123], v[122:123], v[14:15] op_sel_hi:[1,0]
    v_pk_mul_f32 v[124:125], v[124:125], v[14:15] op_sel_hi:[1,0]
    v_pk_mul_f32 v[126:127], v[126:127], v[14:15] op_sel_hi:[1,0]
    v_cvt_pk_bf16_f32 v28, v20, v21
    v_cvt_pk_bf16_f32 v29, v22, v23
    v_add_f32 v7, v20, v21
    v_add_f32 v8, v22, v23
    v_add_f32 v7, v7, v8
    v_fma_f32 v13, v13, v14, v7
    s_waitcnt vmcnt(16)
    v_perm_b32 v36, v148, v144, s91
    v_perm_b32 v38, v148, v144, s92
    v_perm_b32 v37, v156, v152, s91
    v_perm_b32 v39, v156, v152, s92
    v_perm_b32 v40, v149, v145, s91
    v_perm_b32 v42, v149, v145, s92
    v_perm_b32 v41, v157, v153, s91
    v_perm_b32 v43, v157, v153, s92
    v_mfma_f32_16x16x16_bf16 v[96:99], v[36:37], v[28:29], v[96:99]
    v_mfma_f32_16x16x16_bf16 v[100:103], v[38:39], v[28:29], v[100:103]
    v_perm_b32 v44, v150, v146, s91
    v_perm_b32 v46, v150, v146, s92
    v_perm_b32 v45, v158, v154, s91
    v_perm_b32 v47, v158, v154, s92
    v_mfma_f32_16x16x16_bf16 v[104:107], v[40:41], v[28:29], v[104:107]
    v_mfma_f32_16x16x16_bf16 v[108:111], v[42:43], v[28:29], v[108:111]
    v_perm_b32 v48, v151, v147, s91
    v_perm_b32 v50, v151, v147, s92
    v_perm_b32 v49, v159, v155, s91
    v_perm_b32 v51, v159, v155, s92
    v_mfma_f32_16x16x16_bf16 v[112:115], v[44:45], v[28:29], v[112:115]
    v_mfma_f32_16x16x16_bf16 v[116:119], v[46:47], v[28:29], v[116:119]
    v_mfma_f32_16x16x16_bf16 v[120:123], v[48:49], v[28:29], v[120:123]
    v_mfma_f32_16x16x16_bf16 v[124:127], v[50:51], v[28:29], v[124:127]
    s_waitcnt lgkmcnt(0)
    s_mov_b32 s83, s35
    s_cmp_ge_u32 s83, s55
    s_cbranch_scc1 L_drain2
    s_and_b32 s84, s83, 31
    s_lshl_b32 s53, s84, 18
    s_add_u32 s53, s53, s52
    s_lshr_b32 s84, s83, 6
    s_lshl_b32 s84, s84, 15
    s_add_u32 s53, s53, s84
    s_bfe_u32 s84, s83, 0x10005
    s_lshl_b32 s84, s84, 12
    s_add_u32 s53, s53, s84
L_it2:
    s_nop 1
    s_add_u32 s83, s53, 0
    buffer_load_dwordx4 a[80:83], v1, s[44:47], s83 offen offset:0 nt
    buffer_load_dwordx4 a[84:87], v1, s[44:47], s83 offen offset:1024 nt
    buffer_load_dwordx4 a[88:91], v1, s[44:47], s83 offen offset:2048 nt
    buffer_load_dwordx4 a[92:95], v1, s[44:47], s83 offen offset:3072 nt
    s_add_u32 s83, s53, 0
    buffer_load_dwordx4 v[144:147], v1, s[48:51], s83 offen offset:0 nt
    buffer_load_dwordx4 v[148:151], v1, s[48:51], s83 offen offset:1024 nt
    buffer_load_dwordx4 v[152:155], v1, s[48:51], s83 offen offset:2048 nt
    buffer_load_dwordx4 v[156:159], v1, s[48:51], s83 offen offset:3072 nt
    s_waitcnt vmcnt(20)
    ds_write_b128 v83, a[96:99] offset:0
    ds_write_b128 v83, a[100:103] offset:1088
    ds_write_b128 v83, a[104:107] offset:2176
    ds_write_b128 v83, a[108:111] offset:3264
    ds_read_b128 a[160:163], v84 offset:0
    ds_read_b128 a[164:167], v84 offset:64
    ds_read_b128 a[168:171], v84 offset:128
    ds_read_b128 a[172:175], v84 offset:192
    s_waitcnt lgkmcnt(0)
    v_mfma_f32_16x16x32_bf16 v[20:23], a[160:163], a[144:147], 0
    v_mfma_f32_16x16x32_bf16 v[20:23], a[164:167], a[148:151], v[20:23]
    v_mfma_f32_16x16x32_bf16 v[20:23], a[168:171], a[152:155], v[20:23]
    v_mfma_f32_16x16x32_bf16 v[20:23], a[172:175], a[156:159], v[20:23]
    s_mov_b32 s35, 1
    s_atomic_add s35, s[64:65], s90 glc
    s_nop 5
    v_cvt_pk_bf16_f32 v32, v20, v21
    v_cvt_pk_bf16_f32 v33, v22, v23
    v_lshlrev_b32 v20, 16, v32
    v_and_b32 v21, s98, v32
    v_lshlrev_b32 v22, 16, v33
    v_and_b32 v23, s98, v33
    v_pk_mul_f32 v[20:21], v[20:21], s[4:5]
    v_pk_mul_f32 v[22:23], v[22:23], s[4:5]
    v_cvt_pk_bf16_f32 v32, v20, v21
    v_cvt_pk_bf16_f32 v33, v22, v23
    v_lshlrev_b32 v20, 16, v32
    v_and_b32 v21, s98, v32
    v_lshlrev_b32 v22, 16, v33
    v_and_b32 v23, s98, v33
    v_max3_f32 v7, v20, v21, v22
    v_max3_f32 v11, v7, v23, v11
    v_mov_b32 v8, v11
    s_nop 1
    v_permlane32_swap_b32 v11, v8
    v_max_f32 v11, v11, v8
    v_mov_b32 v8, v11
    s_nop 1
    v_permlane16_swap_b32 v11, v8
    v_max_f32 v11, v11, v8
    v_mov_b32 v9, v12
    v_mul_f32 v12, s93, v11
    v_sub_f32 v9, v9, v12
    v_exp_f32 v14, v9
    v_fma_f32 v20, v20, s93, -v12
    v_fma_f32 v21, v21, s93, -v12
    v_fma_f32 v22, v22, s93, -v12
    v_fma_f32 v23, v23, s93, -v12
    v_exp_f32 v20, v20
    v_exp_f32 v21, v21
    v_exp_f32 v22, v22
    v_exp_f32 v23, v23
    v_pk_mul_f32 v[96:97], v[96:97], v[14:15] op_sel_hi:[1,0]
    v_pk_mul_f32 v[98:99], v[98:99], v[14:15] op_sel_hi:[1,0]
    v_pk_mul_f32 v[100:101], v[100:101], v[14:15] op_sel_hi:[1,0]
    v_pk_mul_f32 v[102:103], v[102:103], v[14:15] op_sel_hi:[1,0]
    v_pk_mul_f32 v[104:105], v[104:105], v[14:15] op_sel_hi:[1,0]
    v_pk_mul_f32 v[106:107], v[106:107], v[14:15] op_sel_hi:[1,0]
    v_pk_mul_f32 v[108:109], v[108:109], v[14:15] op_sel_hi:[1,0]
    v_pk_mul_f32 v[110:111], v[110:111], v[14:15] op_sel_hi:[1,0]
    v_pk_mul_f32 v[112:113], v[112:113], v[14:15] op_sel_hi:[1,0]
    v_pk_mul_f32 v[114:115], v[114:115], v[14:15] op_sel_hi:[1,0]
    v_pk_mul_f32 v[116:117], v[116:117], v[14:15] op_sel_hi:[1,0]
    v_pk_mul_f32 v[118:119], v[118:119], v[14:15] op_sel_hi:[1,0]
    v_pk_mul_f32 v[120:121], v[120:121], v[14:15] op_sel_hi:[1,0]
    v_pk_mul_f32 v[122:123], v[122:123], v[14:15] op_sel_hi:[1,0]
    v_pk_mul_f32 v[124:125], v[124:125], v[14:15] op_sel_hi:[1,0]
    v_pk_mul_f32 v[126:127], v[126:127], v[14:15] op_sel_hi:[1,0]
    v_cvt_pk_bf16_f32 v28, v20, v21
    v_cvt_pk_bf16_f32 v29, v22, v23
    v_add_f32 v7, v20, v21
    v_add_f32 v8, v22, v23
    v_add_f32 v7, v7, v8
    v_fma_f32 v13, v13, v14, v7
    s_waitcnt vmcnt(16)
    v_perm_b32 v36, v164, v160, s91
    v_perm_b32 v38, v164, v160, s92
    v_perm_b32 v37, v172, v168, s91
    v_perm_b32 v39, v172, v168, s92
    v_perm_b32 v40, v165, v161, s91
    v_perm_b32 v42, v165, v161, s92
    v_perm_b32 v41, v173, v169, s91
    v_perm_b32 v43, v173, v169, s92
    v_mfma_f32_16x16x16_bf16 v[96:99], v[36:37], v[28:29], v[96:99]
    v_mfma_f32_16x16x16_bf16 v[100:103], v[38:39], v[28:29], v[100:103]
    v_perm_b32 v44, v166, v162, s91
    v_perm_b32 v46, v166, v162, s92
    v_perm_b32 v45, v174, v170, s91
    v_perm_b32 v47, v174, v170, s92
    v_mfma_f32_16x16x16_bf16 v[104:107], v[40:41], v[28:29], v[104:107]
    v_mfma_f32_16x16x16_bf16 v[108:111], v[42:43], v[28:29], v[108:111]
    v_perm_b32 v48, v167, v163, s91
    v_perm_b32 v50, v167, v163, s92
    v_perm_b32 v49, v175, v171, s91
    v_perm_b32 v51, v175, v171, s92
    v_mfma_f32_16x16x16_bf16 v[112:115], v[44:45], v[28:29], v[112:115]
    v_mfma_f32_16x16x16_bf16 v[116:119], v[46:47], v[28:29], v[116:119]
    v_mfma_f32_16x16x16_bf16 v[120:123], v[48:49], v[28:29], v[120:123]
    v_mfma_f32_16x16x16_bf16 v[124:127], v[50:51], v[28:29], v[124:127]
    s_waitcnt lgkmcnt(0)
    s_mov_b32 s83, s35
    s_cmp_ge_u32 s83, s55
    s_cbranch_scc1 L_drain0
    s_and_b32 s84, s83, 31
    s_lshl_b32 s53, s84, 18
    s_add_u32 s53, s53, s52
    s_lshr_b32 s84, s83, 6
    s_lshl_b32 s84, s84, 15
    s_add_u32 s53, s53, s84
    s_bfe_u32 s84, s83, 0x10005
    s_lshl_b32 s84, s84, 12
    s_add_u32 s53, s53, s84
    s_branch L_it0
L_drain0:
    s_nop 1
    s_add_u32 s83, s88, 0
    buffer_load_dwordx4 v[192:195], v2, s[56:59], s83 offen offset:0 nt
    s_add_u32 s83, s88, 16384
    buffer_load_dwordx4 v[196:199], v2, s[56:59], s83 offen offset:0 nt
    s_add_u32 s83, s88, 32768
    buffer_load_dwordx4 v[200:203], v2, s[56:59], s83 offen offset:0 nt
    s_add_u32 s83, s88, 49152
    buffer_load_dwordx4 v[204:207], v2, s[56:59], s83 offen offset:0 nt
    s_waitcnt vmcnt(16)
    ds_write_b128 v83, a[64:67] offset:0
    ds_write_b128 v83, a[68:71] offset:1088
    ds_write_b128 v83, a[72:75] offset:2176
    ds_write_b128 v83, a[76:79] offset:3264
    ds_read_b128 a[160:163], v84 offset:0
    ds_read_b128 a[164:167], v84 offset:64
    ds_read_b128 a[168:171], v84 offset:128
    ds_read_b128 a[172:175], v84 offset:192
    s_waitcnt lgkmcnt(0)
    v_mfma_f32_16x16x32_bf16 v[20:23], a[160:163], a[144:147], 0
    v_mfma_f32_16x16x32_bf16 v[20:23], a[164:167], a[148:151], v[20:23]
    v_mfma_f32_16x16x32_bf16 v[20:23], a[168:171], a[152:155], v[20:23]
    v_mfma_f32_16x16x32_bf16 v[20:23], a[172:175], a[156:159], v[20:23]
    s_nop 7
    v_cvt_pk_bf16_f32 v32, v20, v21
    v_cvt_pk_bf16_f32 v33, v22, v23
    v_lshlrev_b32 v20, 16, v32
    v_and_b32 v21, s98, v32
    v_lshlrev_b32 v22, 16, v33
    v_and_b32 v23, s98, v33
    v_pk_mul_f32 v[20:21], v[20:21], s[4:5]
    v_pk_mul_f32 v[22:23], v[22:23], s[4:5]
    v_cvt_pk_bf16_f32 v32, v20, v21
    v_cvt_pk_bf16_f32 v33, v22, v23
    v_lshlrev_b32 v20, 16, v32
    v_and_b32 v21, s98, v32
    v_lshlrev_b32 v22, 16, v33
    v_and_b32 v23, s98, v33
    v_max3_f32 v7, v20, v21, v22
    v_max3_f32 v11, v7, v23, v11
    v_mov_b32 v8, v11
    s_nop 1
    v_permlane32_swap_b32 v11, v8
    v_max_f32 v11, v11, v8
    v_mov_b32 v8, v11
    s_nop 1
    v_permlane16_swap_b32 v11, v8
    v_max_f32 v11, v11, v8
    v_mov_b32 v9, v12
    v_mul_f32 v12, s93, v11
    v_sub_f32 v9, v9, v12
    v_exp_f32 v14, v9
    v_fma_f32 v20, v20, s93, -v12
    v_fma_f32 v21, v21, s93, -v12
    v_fma_f32 v22, v22, s93, -v12
    v_fma_f32 v23, v23, s93, -v12
    v_exp_f32 v20, v20
    v_exp_f32 v21, v21
    v_exp_f32 v22, v22
    v_exp_f32 v23, v23
    v_pk_mul_f32 v[96:97], v[96:97], v[14:15] op_sel_hi:[1,0]
    v_pk_mul_f32 v[98:99], v[98:99], v[14:15] op_sel_hi:[1,0]
    v_pk_mul_f32 v[100:101], v[100:101], v[14:15] op_sel_hi:[1,0]
    v_pk_mul_f32 v[102:103], v[102:103], v[14:15] op_sel_hi:[1,0]
    v_pk_mul_f32 v[104:105], v[104:105], v[14:15] op_sel_hi:[1,0]
    v_pk_mul_f32 v[106:107], v[106:107], v[14:15] op_sel_hi:[1,0]
    v_pk_mul_f32 v[108:109], v[108:109], v[14:15] op_sel_hi:[1,0]
    v_pk_mul_f32 v[110:111], v[110:111], v[14:15] op_sel_hi:[1,0]
    v_pk_mul_f32 v[112:113], v[112:113], v[14:15] op_sel_hi:[1,0]
    v_pk_mul_f32 v[114:115], v[114:115], v[14:15] op_sel_hi:[1,0]
    v_pk_mul_f32 v[116:117], v[116:117], v[14:15] op_sel_hi:[1,0]
    v_pk_mul_f32 v[118:119], v[118:119], v[14:15] op_sel_hi:[1,0]
    v_pk_mul_f32 v[120:121], v[120:121], v[14:15] op_sel_hi:[1,0]
    v_pk_mul_f32 v[122:123], v[122:123], v[14:15] op_sel_hi:[1,0]
    v_pk_mul_f32 v[124:125], v[124:125], v[14:15] op_sel_hi:[1,0]
    v_pk_mul_f32 v[126:127], v[126:127], v[14:15] op_sel_hi:[1,0]
    v_cvt_pk_bf16_f32 v28, v20, v21
    v_cvt_pk_bf16_f32 v29, v22, v23
    v_add_f32 v7, v20, v21
    v_add_f32 v8, v22, v23
    v_add_f32 v7, v7, v8
    v_fma_f32 v13, v13, v14, v7
    s_add_u32 s83, s88, 2048
    buffer_load_dwordx4 v[208:211], v2, s[56:59], s83 offen offset:0 nt
    s_add_u32 s83, s88, 18432
    buffer_load_dwordx4 v[212:215], v2, s[56:59], s83 offen offset:0 nt
    s_add_u32 s83, s88, 34816
    buffer_load_dwordx4 v[216:219], v2, s[56:59], s83 offen offset:0 nt
    s_add_u32 s83, s88, 51200
    buffer_load_dwordx4 v[220:223], v2, s[56:59], s83 offen offset:0 nt
    s_waitcnt vmcnt(16)
    v_perm_b32 v36, v132, v128, s91
    v_perm_b32 v38, v132, v128, s92
    v_perm_b32 v37, v140, v136, s91
    v_perm_b32 v39, v140, v136, s92
    v_perm_b32 v40, v133, v129, s91
    v_perm_b32 v42, v133, v129, s92
    v_perm_b32 v41, v141, v137, s91
    v_perm_b32 v43, v141, v137, s92
    v_mfma_f32_16x16x16_bf16 v[96:99], v[36:37], v[28:29], v[96:99]
    v_mfma_f32_16x16x16_bf16 v[100:103], v[38:39], v[28:29], v[100:103]
    v_perm_b32 v44, v134, v130, s91
    v_perm_b32 v46, v134, v130, s92
    v_perm_b32 v45, v142, v138, s91
    v_perm_b32 v47, v142, v138, s92
    v_mfma_f32_16x16x16_bf16 v[104:107], v[40:41], v[28:29], v[104:107]
    v_mfma_f32_16x16x16_bf16 v[108:111], v[42:43], v[28:29], v[108:111]
    v_perm_b32 v48, v135, v131, s91
    v_perm_b32 v50, v135, v131, s92
    v_perm_b32 v49, v143, v139, s91
    v_perm_b32 v51, v143, v139, s92
    v_mfma_f32_16x16x16_bf16 v[112:115], v[44:45], v[28:29], v[112:115]
    v_mfma_f32_16x16x16_bf16 v[116:119], v[46:47], v[28:29], v[116:119]
    v_mfma_f32_16x16x16_bf16 v[120:123], v[48:49], v[28:29], v[120:123]
    v_mfma_f32_16x16x16_bf16 v[124:127], v[50:51], v[28:29], v[124:127]
    s_waitcnt vmcnt(12)
    ds_write_b128 v83, a[80:83] offset:0
    ds_write_b128 v83, a[84:87] offset:1088
    ds_write_b128 v83, a[88:91] offset:2176
    ds_write_b128 v83, a[92:95] offset:3264
    ds_read_b128 a[160:163], v84 offset:0
    ds_read_b128 a[164:167], v84 offset:64
    ds_read_b128 a[168:171], v84 offset:128
    ds_read_b128 a[172:175], v84 offset:192
    s_waitcnt lgkmcnt(0)
    v_mfma_f32_16x16x32_bf16 v[20:23], a[160:163], a[144:147], 0
    v_mfma_f32_16x16x32_bf16 v[20:23], a[164:167], a[148:151], v[20:23]
    v_mfma_f32_16x16x32_bf16 v[20:23], a[168:171], a[152:155], v[20:23]
    v_mfma_f32_16x16x32_bf16 v[20:23], a[172:175], a[156:159], v[20:23]
    s_nop 7
    v_cvt_pk_bf16_f32 v32, v20, v21
    v_cvt_pk_bf16_f32 v33, v22, v23
    v_lshlrev_b32 v20, 16, v32
    v_and_b32 v21, s98, v32
    v_lshlrev_b32 v22, 16, v33
    v_and_b32 v23, s98, v33
    v_pk_mul_f32 v[20:21], v[20:21], s[4:5]
    v_pk_mul_f32 v[22:23], v[22:23], s[4:5]
    v_cvt_pk_bf16_f32 v32, v20, v21
    v_cvt_pk_bf16_f32 v33, v22, v23
    v_lshlrev_b32 v20, 16, v32
    v_and_b32 v21, s98, v32
    v_lshlrev_b32 v22, 16, v33
    v_and_b32 v23, s98, v33
    v_max3_f32 v7, v20, v21, v22
    v_max3_f32 v11, v7, v23, v11
    v_mov_b32 v8, v11
    s_nop 1
    v_permlane32_swap_b32 v11, v8
    v_max_f32 v11, v11, v8
    v_mov_b32 v8, v11
    s_nop 1
    v_permlane16_swap_b32 v11, v8
    v_max_f32 v11, v11, v8
    v_mov_b32 v9, v12
    v_mul_f32 v12, s93, v11
    v_sub_f32 v9, v9, v12
    v_exp_f32 v14, v9
    v_fma_f32 v20, v20, s93, -v12
    v_fma_f32 v21, v21, s93, -v12
    v_fma_f32 v22, v22, s93, -v12
    v_fma_f32 v23, v23, s93, -v12
    v_exp_f32 v20, v20
    v_exp_f32 v21, v21
    v_exp_f32 v22, v22
    v_exp_f32 v23, v23
    v_pk_mul_f32 v[96:97], v[96:97], v[14:15] op_sel_hi:[1,0]
    v_pk_mul_f32 v[98:99], v[98:99], v[14:15] op_sel_hi:[1,0]
    v_pk_mul_f32 v[100:101], v[100:101], v[14:15] op_sel_hi:[1,0]
    v_pk_mul_f32 v[102:103], v[102:103], v[14:15] op_sel_hi:[1,0]
    v_pk_mul_f32 v[104:105], v[104:105], v[14:15] op_sel_hi:[1,0]
    v_pk_mul_f32 v[106:107], v[106:107], v[14:15] op_sel_hi:[1,0]
    v_pk_mul_f32 v[108:109], v[108:109], v[14:15] op_sel_hi:[1,0]
    v_pk_mul_f32 v[110:111], v[110:111], v[14:15] op_sel_hi:[1,0]
    v_pk_mul_f32 v[112:113], v[112:113], v[14:15] op_sel_hi:[1,0]
    v_pk_mul_f32 v[114:115], v[114:115], v[14:15] op_sel_hi:[1,0]
    v_pk_mul_f32 v[116:117], v[116:117], v[14:15] op_sel_hi:[1,0]
    v_pk_mul_f32 v[118:119], v[118:119], v[14:15] op_sel_hi:[1,0]
    v_pk_mul_f32 v[120:121], v[120:121], v[14:15] op_sel_hi:[1,0]
    v_pk_mul_f32 v[122:123], v[122:123], v[14:15] op_sel_hi:[1,0]
    v_pk_mul_f32 v[124:125], v[124:125], v[14:15] op_sel_hi:[1,0]
    v_pk_mul_f32 v[126:127], v[126:127], v[14:15] op_sel_hi:[1,0]
    v_cvt_pk_bf16_f32 v28, v20, v21
    v_cvt_pk_bf16_f32 v29, v22, v23
    v_add_f32 v7, v20, v21
    v_add_f32 v8, v22, v23
    v_add_f32 v7, v7, v8
    v_fma_f32 v13, v13, v14, v7
    v_mov_b32 v8, v13
    s_nop 1
    v_permlane32_swap_b32 v13, v8
    v_add_f32 v13, v13, v8
    v_mov_b32 v8, v13
    s_nop 1
    v_permlane16_swap_b32 v13, v8
    v_add_f32 v13, v13, v8
    v_mov_b32 v8, v11
    v_mov_b32 v9, v13
    s_mov_b64 exec, 0xff
    ds_write_b64 v17, v[8:9] offset:5376
    s_mov_b64 exec, -1
    s_mov_b32 s6, 0x00ff00ff
    s_mov_b32 s7, 0x00ff00ff
    s_waitcnt vmcnt(8)
    v_perm_b32 v36, v148, v144, s91
    v_perm_b32 v38, v148, v144, s92
    v_perm_b32 v37, v156, v152, s91
    v_perm_b32 v39, v156, v152, s92
    v_perm_b32 v40, v149, v145, s91
    v_perm_b32 v42, v149, v145, s92
    v_perm_b32 v41, v157, v153, s91
    v_perm_b32 v43, v157, v153, s92
    v_mfma_f32_16x16x16_bf16 v[96:99], v[36:37], v[28:29], v[96:99]
    v_mfma_f32_16x16x16_bf16 v[100:103], v[38:39], v[28:29], v[100:103]
    v_perm_b32 v44, v150, v146, s91
    v_perm_b32 v46, v150, v146, s92
    v_perm_b32 v45, v158, v154, s91
    v_perm_b32 v47, v158, v154, s92
    v_mfma_f32_16x16x16_bf16 v[104:107], v[40:41], v[28:29], v[104:107]
    v_mfma_f32_16x16x16_bf16 v[108:111], v[42:43], v[28:29], v[108:111]
    v_perm_b32 v48, v151, v147, s91
    v_perm_b32 v50, v151, v147, s92
    v_perm_b32 v49, v159, v155, s91
    v_perm_b32 v51, v159, v155, s92
    v_mfma_f32_16x16x16_bf16 v[112:115], v[44:45], v[28:29], v[112:115]
    v_mfma_f32_16x16x16_bf16 v[116:119], v[46:47], v[28:29], v[116:119]
    v_mfma_f32_16x16x16_bf16 v[120:123], v[48:49], v[28:29], v[120:123]
    v_mfma_f32_16x16x16_bf16 v[124:127], v[50:51], v[28:29], v[124:127]
    s_mov_b64 exec, s[6:7]
    ds_write_b128 v16, v[96:99] offset:25088
    ds_write_b128 v16, v[100:103] offset:25104
    ds_write_b128 v16, v[104:107] offset:25120
    ds_write_b128 v16, v[108:111] offset:25136
    ds_write_b128 v16, v[112:115] offset:25152
    ds_write_b128 v16, v[116:119] offset:25168
    ds_write_b128 v16, v[120:123] offset:25184
    ds_write_b128 v16, v[124:127] offset:25200
    s_mov_b64 exec, 1
    ds_add_u32 v3, v4 offset:12
    s_mov_b64 exec, -1
    s_cmp_ge_u32 s3, 2
    s_cbranch_scc1 L_tailG
    s_branch L_tailM
L_drain1:
    s_nop 1
    s_add_u32 s83, s88, 0
    buffer_load_dwordx4 v[192:195], v2, s[56:59], s83 offen offset:0 nt
    s_add_u32 s83, s88, 16384
    buffer_load_dwordx4 v[196:199], v2, s[56:59], s83 offen offset:0 nt
    s_add_u32 s83, s88, 32768
    buffer_load_dwordx4 v[200:203], v2, s[56:59], s83 offen offset:0 nt
    s_add_u32 s83, s88, 49152
    buffer_load_dwordx4 v[204:207], v2, s[56:59], s83 offen offset:0 nt
    s_waitcnt vmcnt(16)
    ds_write_b128 v83, a[80:83] offset:0
    ds_write_b128 v83, a[84:87] offset:1088
    ds_write_b128 v83, a[88:91] offset:2176
    ds_write_b128 v83, a[92:95] offset:3264
    ds_read_b128 a[160:163], v84 offset:0
    ds_read_b128 a[164:167], v84 offset:64
    ds_read_b128 a[168:171], v84 offset:128
    ds_read_b128 a[172:175], v84 offset:192
    s_waitcnt lgkmcnt(0)
    v_mfma_f32_16x16x32_bf16 v[20:23], a[160:163], a[144:147], 0
    v_mfma_f32_16x16x32_bf16 v[20:23], a[164:167], a[148:151], v[20:23]
    v_mfma_f32_16x16x32_bf16 v[20:23], a[168:171], a[152:155], v[20:23]
    v_mfma_f32_16x16x32_bf16 v[20:23], a[172:175], a[156:159], v[20:23]
    s_nop 7
    v_cvt_pk_bf16_f32 v32, v20, v21
    v_cvt_pk_bf16_f32 v33, v22, v23
    v_lshlrev_b32 v20, 16, v32
    v_and_b32 v21, s98, v32
    v_lshlrev_b32 v22, 16, v33
    v_and_b32 v23, s98, v33
    v_pk_mul_f32 v[20:21], v[20:21], s[4:5]
    v_pk_mul_f32 v[22:23], v[22:23], s[4:5]
    v_cvt_pk_bf16_f32 v32, v20, v21
    v_cvt_pk_bf16_f32 v33, v22, v23
    v_lshlrev_b32 v20, 16, v32
    v_and_b32 v21, s98, v32
    v_lshlrev_b32 v22, 16, v33
    v_and_b32 v23, s98, v33
    v_max3_f32 v7, v20, v21, v22
    v_max3_f32 v11, v7, v23, v11
    v_mov_b32 v8, v11
    s_nop 1
    v_permlane32_swap_b32 v11, v8
    v_max_f32 v11, v11, v8
    v_mov_b32 v8, v11
    s_nop 1
    v_permlane16_swap_b32 v11, v8
    v_max_f32 v11, v11, v8
    v_mov_b32 v9, v12
    v_mul_f32 v12, s93, v11
    v_sub_f32 v9, v9, v12
    v_exp_f32 v14, v9
    v_fma_f32 v20, v20, s93, -v12
    v_fma_f32 v21, v21, s93, -v12
    v_fma_f32 v22, v22, s93, -v12
    v_fma_f32 v23, v23, s93, -v12
    v_exp_f32 v20, v20
    v_exp_f32 v21, v21
    v_exp_f32 v22, v22
    v_exp_f32 v23, v23
    v_pk_mul_f32 v[96:97], v[96:97], v[14:15] op_sel_hi:[1,0]
    v_pk_mul_f32 v[98:99], v[98:99], v[14:15] op_sel_hi:[1,0]
    v_pk_mul_f32 v[100:101], v[100:101], v[14:15] op_sel_hi:[1,0]
    v_pk_mul_f32 v[102:103], v[102:103], v[14:15] op_sel_hi:[1,0]
    v_pk_mul_f32 v[104:105], v[104:105], v[14:15] op_sel_hi:[1,0]
    v_pk_mul_f32 v[106:107], v[106:107], v[14:15] op_sel_hi:[1,0]
    v_pk_mul_f32 v[108:109], v[108:109], v[14:15] op_sel_hi:[1,0]
    v_pk_mul_f32 v[110:111], v[110:111], v[14:15] op_sel_hi:[1,0]
    v_pk_mul_f32 v[112:113], v[112:113], v[14:15] op_sel_hi:[1,0]
    v_pk_mul_f32 v[114:115], v[114:115], v[14:15] op_sel_hi:[1,0]
    v_pk_mul_f32 v[116:117], v[116:117], v[14:15] op_sel_hi:[1,0]
    v_pk_mul_f32 v[118:119], v[118:119], v[14:15] op_sel_hi:[1,0]
    v_pk_mul_f32 v[120:121], v[120:121], v[14:15] op_sel_hi:[1,0]
    v_pk_mul_f32 v[122:123], v[122:123], v[14:15] op_sel_hi:[1,0]
    v_pk_mul_f32 v[124:125], v[124:125], v[14:15] op_sel_hi:[1,0]
    v_pk_mul_f32 v[126:127], v[126:127], v[14:15] op_sel_hi:[1,0]
    v_cvt_pk_bf16_f32 v28, v20, v21
    v_cvt_pk_bf16_f32 v29, v22, v23
    v_add_f32 v7, v20, v21
    v_add_f32 v8, v22, v23
    v_add_f32 v7, v7, v8
    v_fma_f32 v13, v13, v14, v7
    s_add_u32 s83, s88, 2048
    buffer_load_dwordx4 v[208:211], v2, s[56:59], s83 offen offset:0 nt
    s_add_u32 s83, s88, 18432
    buffer_load_dwordx4 v[212:215], v2, s[56:59], s83 offen offset:0 nt
    s_add_u32 s83, s88, 34816
    buffer_load_dwordx4 v[216:219], v2, s[56:59], s83 offen offset:0 nt
    s_add_u32 s83, s88, 51200
    buffer_load_dwordx4 v[220:223], v2, s[56:59], s83 offen offset:0 nt
    s_waitcnt vmcnt(16)
    v_perm_b32 v36, v148, v144, s91
    v_perm_b32 v38, v148, v144, s92
    v_perm_b32 v37, v156, v152, s91
    v_perm_b32 v39, v156, v152, s92
    v_perm_b32 v40, v149, v145, s91
    v_perm_b32 v42, v149, v145, s92
    v_perm_b32 v41, v157, v153, s91
    v_perm_b32 v43, v157, v153, s92
    v_mfma_f32_16x16x16_bf16 v[96:99], v[36:37], v[28:29], v[96:99]
    v_mfma_f32_16x16x16_bf16 v[100:103], v[38:39], v[28:29], v[100:103]
    v_perm_b32 v44, v150, v146, s91
    v_perm_b32 v46, v150, v146, s92
    v_perm_b32 v45, v158, v154, s91
    v_perm_b32 v47, v158, v154, s92
    v_mfma_f32_16x16x16_bf16 v[104:107], v[40:41], v[28:29], v[104:107]
    v_mfma_f32_16x16x16_bf16 v[108:111], v[42:43], v[28:29], v[108:111]
    v_perm_b32 v48, v151, v147, s91
    v_perm_b32 v50, v151, v147, s92
    v_perm_b32 v49, v159, v155, s91
    v_perm_b32 v51, v159, v155, s92
    v_mfma_f32_16x16x16_bf16 v[112:115], v[44:45], v[28:29], v[112:115]
    v_mfma_f32_16x16x16_bf16 v[116:119], v[46:47], v[28:29], v[116:119]
    v_mfma_f32_16x16x16_bf16 v[120:123], v[48:49], v[28:29], v[120:123]
    v_mfma_f32_16x16x16_bf16 v[124:127], v[50:51], v[28:29], v[124:127]
    s_waitcnt vmcnt(12)
    ds_write_b128 v83, a[96:99] offset:0
    ds_write_b128 v83, a[100:103] offset:1088
    ds_write_b128 v83, a[104:107] offset:2176
    ds_write_b128 v83, a[108:111] offset:3264
    ds_read_b128 a[160:163], v84 offset:0
    ds_read_b128 a[164:167], v84 offset:64
    ds_read_b128 a[168:171], v84 offset:128
    ds_read_b128 a[172:175], v84 offset:192
    s_waitcnt lgkmcnt(0)
    v_mfma_f32_16x16x32_bf16 v[20:23], a[160:163], a[144:147], 0
    v_mfma_f32_16x16x32_bf16 v[20:23], a[164:167], a[148:151], v[20:23]
    v_mfma_f32_16x16x32_bf16 v[20:23], a[168:171], a[152:155], v[20:23]
    v_mfma_f32_16x16x32_bf16 v[20:23], a[172:175], a[156:159], v[20:23]
    s_nop 7
    v_cvt_pk_bf16_f32 v32, v20, v21
    v_cvt_pk_bf16_f32 v33, v22, v23
    v_lshlrev_b32 v20, 16, v32
    v_and_b32 v21, s98, v32
    v_lshlrev_b32 v22, 16, v33
    v_and_b32 v23, s98, v33
    v_pk_mul_f32 v[20:21], v[20:21], s[4:5]
    v_pk_mul_f32 v[22:23], v[22:23], s[4:5]
    v_cvt_pk_bf16_f32 v32, v20, v21
    v_cvt_pk_bf16_f32 v33, v22, v23
    v_lshlrev_b32 v20, 16, v32
    v_and_b32 v21, s98, v32
    v_lshlrev_b32 v22, 16, v33
    v_and_b32 v23, s98, v33
    v_max3_f32 v7, v20, v21, v22
    v_max3_f32 v11, v7, v23, v11
    v_mov_b32 v8, v11
    s_nop 1
    v_permlane32_swap_b32 v11, v8
    v_max_f32 v11, v11, v8
    v_mov_b32 v8, v11
    s_nop 1
    v_permlane16_swap_b32 v11, v8
    v_max_f32 v11, v11, v8
    v_mov_b32 v9, v12
    v_mul_f32 v12, s93, v11
    v_sub_f32 v9, v9, v12
    v_exp_f32 v14, v9
    v_fma_f32 v20, v20, s93, -v12
    v_fma_f32 v21, v21, s93, -v12
    v_fma_f32 v22, v22, s93, -v12
    v_fma_f32 v23, v23, s93, -v12
    v_exp_f32 v20, v20
    v_exp_f32 v21, v21
    v_exp_f32 v22, v22
    v_exp_f32 v23, v23
    v_pk_mul_f32 v[96:97], v[96:97], v[14:15] op_sel_hi:[1,0]
    v_pk_mul_f32 v[98:99], v[98:99], v[14:15] op_sel_hi:[1,0]
    v_pk_mul_f32 v[100:101], v[100:101], v[14:15] op_sel_hi:[1,0]
    v_pk_mul_f32 v[102:103], v[102:103], v[14:15] op_sel_hi:[1,0]
    v_pk_mul_f32 v[104:105], v[104:105], v[14:15] op_sel_hi:[1,0]
    v_pk_mul_f32 v[106:107], v[106:107], v[14:15] op_sel_hi:[1,0]
    v_pk_mul_f32 v[108:109], v[108:109], v[14:15] op_sel_hi:[1,0]
    v_pk_mul_f32 v[110:111], v[110:111], v[14:15] op_sel_hi:[1,0]
    v_pk_mul_f32 v[112:113], v[112:113], v[14:15] op_sel_hi:[1,0]
    v_pk_mul_f32 v[114:115], v[114:115], v[14:15] op_sel_hi:[1,0]
    v_pk_mul_f32 v[116:117], v[116:117], v[14:15] op_sel_hi:[1,0]
    v_pk_mul_f32 v[118:119], v[118:119], v[14:15] op_sel_hi:[1,0]
    v_pk_mul_f32 v[120:121], v[120:121], v[14:15] op_sel_hi:[1,0]
    v_pk_mul_f32 v[122:123], v[122:123], v[14:15] op_sel_hi:[1,0]
    v_pk_mul_f32 v[124:125], v[124:125], v[14:15] op_sel_hi:[1,0]
    v_pk_mul_f32 v[126:127], v[126:127], v[14:15] op_sel_hi:[1,0]
    v_cvt_pk_bf16_f32 v28, v20, v21
    v_cvt_pk_bf16_f32 v29, v22, v23
    v_add_f32 v7, v20, v21
    v_add_f32 v8, v22, v23
    v_add_f32 v7, v7, v8
    v_fma_f32 v13, v13, v14, v7
    v_mov_b32 v8, v13
    s_nop 1
    v_permlane32_swap_b32 v13, v8
    v_add_f32 v13, v13, v8
    v_mov_b32 v8, v13
    s_nop 1
    v_permlane16_swap_b32 v13, v8
    v_add_f32 v13, v13, v8
    v_mov_b32 v8, v11
    v_mov_b32 v9, v13
    s_mov_b64 exec, 0xff
    ds_write_b64 v17, v[8:9] offset:5376
    s_mov_b64 exec, -1
    s_mov_b32 s6, 0x00ff00ff
    s_mov_b32 s7, 0x00ff00ff
    s_waitcnt vmcnt(8)
    v_perm_b32 v36, v164, v160, s91
    v_perm_b32 v38, v164, v160, s92
    v_perm_b32 v37, v172, v168, s91
    v_perm_b32 v39, v172, v168, s92
    v_perm_b32 v40, v165, v161, s91
    v_perm_b32 v42, v165, v161, s92
    v_perm_b32 v41, v173, v169, s91
    v_perm_b32 v43, v173, v169, s92
    v_mfma_f32_16x16x16_bf16 v[96:99], v[36:37], v[28:29], v[96:99]
    v_mfma_f32_16x16x16_bf16 v[100:103], v[38:39], v[28:29], v[100:103]
    v_perm_b32 v44, v166, v162, s91
    v_perm_b32 v46, v166, v162, s92
    v_perm_b32 v45, v174, v170, s91
    v_perm_b32 v47, v174, v170, s92
    v_mfma_f32_16x16x16_bf16 v[104:107], v[40:41], v[28:29], v[104:107]
    v_mfma_f32_16x16x16_bf16 v[108:111], v[42:43], v[28:29], v[108:111]
    v_perm_b32 v48, v167, v163, s91
    v_perm_b32 v50, v167, v163, s92
    v_perm_b32 v49, v175, v171, s91
    v_perm_b32 v51, v175, v171, s92
    v_mfma_f32_16x16x16_bf16 v[112:115], v[44:45], v[28:29], v[112:115]
    v_mfma_f32_16x16x16_bf16 v[116:119], v[46:47], v[28:29], v[116:119]
    v_mfma_f32_16x16x16_bf16 v[120:123], v[48:49], v[28:29], v[120:123]
    v_mfma_f32_16x16x16_bf16 v[124:127], v[50:51], v[28:29], v[124:127]
    s_mov_b64 exec, s[6:7]
    ds_write_b128 v16, v[96:99] offset:25088
    ds_write_b128 v16, v[100:103] offset:25104
    ds_write_b128 v16, v[104:107] offset:25120
    ds_write_b128 v16, v[108:111] offset:25136
    ds_write_b128 v16, v[112:115] offset:25152
    ds_write_b128 v16, v[116:119] offset:25168
    ds_write_b128 v16, v[120:123] offset:25184
    ds_write_b128 v16, v[124:127] offset:25200
    s_mov_b64 exec, 1
    ds_add_u32 v3, v4 offset:12
    s_mov_b64 exec, -1
    s_cmp_ge_u32 s3, 2
    s_cbranch_scc1 L_tailG
    s_branch L_tailM
L_drain2:
    s_nop 1
    s_add_u32 s83, s88, 0
    buffer_load_dwordx4 v[192:195], v2, s[56:59], s83 offen offset:0 nt
    s_add_u32 s83, s88, 16384
    buffer_load_dwordx4 v[196:199], v2, s[56:59], s83 offen offset:0 nt
    s_add_u32 s83, s88, 32768
    buffer_load_dwordx4 v[200:203], v2, s[56:59], s83 offen offset:0 nt
    s_add_u32 s83, s88, 49152
    buffer_load_dwordx4 v[204:207], v2, s[56:59], s83 offen offset:0 nt
    s_waitcnt vmcnt(16)
    ds_write_b128 v83, a[96:99] offset:0
    ds_write_b128 v83, a[100:103] offset:1088
    ds_write_b128 v83, a[104:107] offset:2176
    ds_write_b128 v83, a[108:111] offset:3264
    ds_read_b128 a[160:163], v84 offset:0
    ds_read_b128 a[164:167], v84 offset:64
    ds_read_b128 a[168:171], v84 offset:128
    ds_read_b128 a[172:175], v84 offset:192
    s_waitcnt lgkmcnt(0)
    v_mfma_f32_16x16x32_bf16 v[20:23], a[160:163], a[144:147], 0
    v_mfma_f32_16x16x32_bf16 v[20:23], a[164:167], a[148:151], v[20:23]
    v_mfma_f32_16x16x32_bf16 v[20:23], a[168:171], a[152:155], v[20:23]
    v_mfma_f32_16x16x32_bf16 v[20:23], a[172:175], a[156:159], v[20:23]
    s_nop 7
    v_cvt_pk_bf16_f32 v32, v20, v21
    v_cvt_pk_bf16_f32 v33, v22, v23
    v_lshlrev_b32 v20, 16, v32
    v_and_b32 v21, s98, v32
    v_lshlrev_b32 v22, 16, v33
    v_and_b32 v23, s98, v33
    v_pk_mul_f32 v[20:21], v[20:21], s[4:5]
    v_pk_mul_f32 v[22:23], v[22:23], s[4:5]
    v_cvt_pk_bf16_f32 v32, v20, v21
    v_cvt_pk_bf16_f32 v33, v22, v23
    v_lshlrev_b32 v20, 16, v32
    v_and_b32 v21, s98, v32
    v_lshlrev_b32 v22, 16, v33
    v_and_b32 v23, s98, v33
    v_max3_f32 v7, v20, v21, v22
    v_max3_f32 v11, v7, v23, v11
    v_mov_b32 v8, v11
    s_nop 1
    v_permlane32_swap_b32 v11, v8
    v_max_f32 v11, v11, v8
    v_mov_b32 v8, v11
    s_nop 1
    v_permlane16_swap_b32 v11, v8
    v_max_f32 v11, v11, v8
    v_mov_b32 v9, v12
    v_mul_f32 v12, s93, v11
    v_sub_f32 v9, v9, v12
    v_exp_f32 v14, v9
    v_fma_f32 v20, v20, s93, -v12
    v_fma_f32 v21, v21, s93, -v12
    v_fma_f32 v22, v22, s93, -v12
    v_fma_f32 v23, v23, s93, -v12
    v_exp_f32 v20, v20
    v_exp_f32 v21, v21
    v_exp_f32 v22, v22
    v_exp_f32 v23, v23
    v_pk_mul_f32 v[96:97], v[96:97], v[14:15] op_sel_hi:[1,0]
    v_pk_mul_f32 v[98:99], v[98:99], v[14:15] op_sel_hi:[1,0]
    v_pk_mul_f32 v[100:101], v[100:101], v[14:15] op_sel_hi:[1,0]
    v_pk_mul_f32 v[102:103], v[102:103], v[14:15] op_sel_hi:[1,0]
    v_pk_mul_f32 v[104:105], v[104:105], v[14:15] op_sel_hi:[1,0]
    v_pk_mul_f32 v[106:107], v[106:107], v[14:15] op_sel_hi:[1,0]
    v_pk_mul_f32 v[108:109], v[108:109], v[14:15] op_sel_hi:[1,0]
    v_pk_mul_f32 v[110:111], v[110:111], v[14:15] op_sel_hi:[1,0]
    v_pk_mul_f32 v[112:113], v[112:113], v[14:15] op_sel_hi:[1,0]
    v_pk_mul_f32 v[114:115], v[114:115], v[14:15] op_sel_hi:[1,0]
    v_pk_mul_f32 v[116:117], v[116:117], v[14:15] op_sel_hi:[1,0]
    v_pk_mul_f32 v[118:119], v[118:119], v[14:15] op_sel_hi:[1,0]
    v_pk_mul_f32 v[120:121], v[120:121], v[14:15] op_sel_hi:[1,0]
    v_pk_mul_f32 v[122:123], v[122:123], v[14:15] op_sel_hi:[1,0]
    v_pk_mul_f32 v[124:125], v[124:125], v[14:15] op_sel_hi:[1,0]
    v_pk_mul_f32 v[126:127], v[126:127], v[14:15] op_sel_hi:[1,0]
    v_cvt_pk_bf16_f32 v28, v20, v21
    v_cvt_pk_bf16_f32 v29, v22, v23
    v_add_f32 v7, v20, v21
    v_add_f32 v8, v22, v23
    v_add_f32 v7, v7, v8
    v_fma_f32 v13, v13, v14, v7
    s_add_u32 s83, s88, 2048
    buffer_load_dwordx4 v[208:211], v2, s[56:59], s83 offen offset:0 nt
    s_add_u32 s83, s88, 18432
    buffer_load_dwordx4 v[212:215], v2, s[56:59], s83 offen offset:0 nt
    s_add_u32 s83, s88, 34816
    buffer_load_dwordx4 v[216:219], v2, s[56:59], s83 offen offset:0 nt
    s_add_u32 s83, s88, 51200
    buffer_load_dwordx4 v[220:223], v2, s[56:59], s83 offen offset:0 nt
    s_waitcnt vmcnt(16)
    v_perm_b32 v36, v164, v160, s91
    v_perm_b32 v38, v164, v160, s92
    v_perm_b32 v37, v172, v168, s91
    v_perm_b32 v39, v172, v168, s92
    v_perm_b32 v40, v165, v161, s91
    v_perm_b32 v42, v165, v161, s92
    v_perm_b32 v41, v173, v169, s91
    v_perm_b32 v43, v173, v169, s92
    v_mfma_f32_16x16x16_bf16 v[96:99], v[36:37], v[28:29], v[96:99]
    v_mfma_f32_16x16x16_bf16 v[100:103], v[38:39], v[28:29], v[100:103]
    v_perm_b32 v44, v166, v162, s91
    v_perm_b32 v46, v166, v162, s92
    v_perm_b32 v45, v174, v170, s91
    v_perm_b32 v47, v174, v170, s92
    v_mfma_f32_16x16x16_bf16 v[104:107], v[40:41], v[28:29], v[104:107]
    v_mfma_f32_16x16x16_bf16 v[108:111], v[42:43], v[28:29], v[108:111]
    v_perm_b32 v48, v167, v163, s91
    v_perm_b32 v50, v167, v163, s92
    v_perm_b32 v49, v175, v171, s91
    v_perm_b32 v51, v175, v171, s92
    v_mfma_f32_16x16x16_bf16 v[112:115], v[44:45], v[28:29], v[112:115]
    v_mfma_f32_16x16x16_bf16 v[116:119], v[46:47], v[28:29], v[116:119]
    v_mfma_f32_16x16x16_bf16 v[120:123], v[48:49], v[28:29], v[120:123]
    v_mfma_f32_16x16x16_bf16 v[124:127], v[50:51], v[28:29], v[124:127]
    s_waitcnt vmcnt(12)
    ds_write_b128 v83, a[64:67] offset:0
    ds_write_b128 v83, a[68:71] offset:1088
    ds_write_b128 v83, a[72:75] offset:2176
    ds_write_b128 v83, a[76:79] offset:3264
    ds_read_b128 a[160:163], v84 offset:0
    ds_read_b128 a[164:167], v84 offset:64
    ds_read_b128 a[168:171], v84 offset:128
    ds_read_b128 a[172:175], v84 offset:192
    s_waitcnt lgkmcnt(0)
    v_mfma_f32_16x16x32_bf16 v[20:23], a[160:163], a[144:147], 0
    v_mfma_f32_16x16x32_bf16 v[20:23], a[164:167], a[148:151], v[20:23]
    v_mfma_f32_16x16x32_bf16 v[20:23], a[168:171], a[152:155], v[20:23]
    v_mfma_f32_16x16x32_bf16 v[20:23], a[172:175], a[156:159], v[20:23]
    s_nop 7
    v_cvt_pk_bf16_f32 v32, v20, v21
    v_cvt_pk_bf16_f32 v33, v22, v23
    v_lshlrev_b32 v20, 16, v32
    v_and_b32 v21, s98, v32
    v_lshlrev_b32 v22, 16, v33
    v_and_b32 v23, s98, v33
    v_pk_mul_f32 v[20:21], v[20:21], s[4:5]
    v_pk_mul_f32 v[22:23], v[22:23], s[4:5]
    v_cvt_pk_bf16_f32 v32, v20, v21
    v_cvt_pk_bf16_f32 v33, v22, v23
    v_lshlrev_b32 v20, 16, v32
    v_and_b32 v21, s98, v32
    v_lshlrev_b32 v22, 16, v33
    v_and_b32 v23, s98, v33
    v_max3_f32 v7, v20, v21, v22
    v_max3_f32 v11, v7, v23, v11
    v_mov_b32 v8, v11
    s_nop 1
    v_permlane32_swap_b32 v11, v8
    v_max_f32 v11, v11, v8
    v_mov_b32 v8, v11
    s_nop 1
    v_permlane16_swap_b32 v11, v8
    v_max_f32 v11, v11, v8
    v_mov_b32 v9, v12
    v_mul_f32 v12, s93, v11
    v_sub_f32 v9, v9, v12
    v_exp_f32 v14, v9
    v_fma_f32 v20, v20, s93, -v12
    v_fma_f32 v21, v21, s93, -v12
    v_fma_f32 v22, v22, s93, -v12
    v_fma_f32 v23, v23, s93, -v12
    v_exp_f32 v20, v20
    v_exp_f32 v21, v21
    v_exp_f32 v22, v22
    v_exp_f32 v23, v23
    v_pk_mul_f32 v[96:97], v[96:97], v[14:15] op_sel_hi:[1,0]
    v_pk_mul_f32 v[98:99], v[98:99], v[14:15] op_sel_hi:[1,0]
    v_pk_mul_f32 v[100:101], v[100:101], v[14:15] op_sel_hi:[1,0]
    v_pk_mul_f32 v[102:103], v[102:103], v[14:15] op_sel_hi:[1,0]
    v_pk_mul_f32 v[104:105], v[104:105], v[14:15] op_sel_hi:[1,0]
    v_pk_mul_f32 v[106:107], v[106:107], v[14:15] op_sel_hi:[1,0]
    v_pk_mul_f32 v[108:109], v[108:109], v[14:15] op_sel_hi:[1,0]
    v_pk_mul_f32 v[110:111], v[110:111], v[14:15] op_sel_hi:[1,0]
    v_pk_mul_f32 v[112:113], v[112:113], v[14:15] op_sel_hi:[1,0]
    v_pk_mul_f32 v[114:115], v[114:115], v[14:15] op_sel_hi:[1,0]
    v_pk_mul_f32 v[116:117], v[116:117], v[14:15] op_sel_hi:[1,0]
    v_pk_mul_f32 v[118:119], v[118:119], v[14:15] op_sel_hi:[1,0]
    v_pk_mul_f32 v[120:121], v[120:121], v[14:15] op_sel_hi:[1,0]
    v_pk_mul_f32 v[122:123], v[122:123], v[14:15] op_sel_hi:[1,0]
    v_pk_mul_f32 v[124:125], v[124:125], v[14:15] op_sel_hi:[1,0]
    v_pk_mul_f32 v[126:127], v[126:127], v[14:15] op_sel_hi:[1,0]
    v_cvt_pk_bf16_f32 v28, v20, v21
    v_cvt_pk_bf16_f32 v29, v22, v23
    v_add_f32 v7, v20, v21
    v_add_f32 v8, v22, v23
    v_add_f32 v7, v7, v8
    v_fma_f32 v13, v13, v14, v7
    v_mov_b32 v8, v13
    s_nop 1
    v_permlane32_swap_b32 v13, v8
    v_add_f32 v13, v13, v8
    v_mov_b32 v8, v13
    s_nop 1
    v_permlane16_swap_b32 v13, v8
    v_add_f32 v13, v13, v8
    v_mov_b32 v8, v11
    v_mov_b32 v9, v13
    s_mov_b64 exec, 0xff
    ds_write_b64 v17, v[8:9] offset:5376
    s_mov_b64 exec, -1
    s_mov_b32 s6, 0x00ff00ff
    s_mov_b32 s7, 0x00ff00ff
    s_waitcnt vmcnt(8)
    v_perm_b32 v36, v132, v128, s91
    v_perm_b32 v38, v132, v128, s92
    v_perm_b32 v37, v140, v136, s91
    v_perm_b32 v39, v140, v136, s92
    v_perm_b32 v40, v133, v129, s91
    v_perm_b32 v42, v133, v129, s92
    v_perm_b32 v41, v141, v137, s91
    v_perm_b32 v43, v141, v137, s92
    v_mfma_f32_16x16x16_bf16 v[96:99], v[36:37], v[28:29], v[96:99]
    v_mfma_f32_16x16x16_bf16 v[100:103], v[38:39], v[28:29], v[100:103]
    v_perm_b32 v44, v134, v130, s91
    v_perm_b32 v46, v134, v130, s92
    v_perm_b32 v45, v142, v138, s91
    v_perm_b32 v47, v142, v138, s92
    v_mfma_f32_16x16x16_bf16 v[104:107], v[40:41], v[28:29], v[104:107]
    v_mfma_f32_16x16x16_bf16 v[108:111], v[42:43], v[28:29], v[108:111]
    v_perm_b32 v48, v135, v131, s91
    v_perm_b32 v50, v135, v131, s92
    v_perm_b32 v49, v143, v139, s91
    v_perm_b32 v51, v143, v139, s92
    v_mfma_f32_16x16x16_bf16 v[112:115], v[44:45], v[28:29], v[112:115]
    v_mfma_f32_16x16x16_bf16 v[116:119], v[46:47], v[28:29], v[116:119]
    v_mfma_f32_16x16x16_bf16 v[120:123], v[48:49], v[28:29], v[120:123]
    v_mfma_f32_16x16x16_bf16 v[124:127], v[50:51], v[28:29], v[124:127]
    s_mov_b64 exec, s[6:7]
    ds_write_b128 v16, v[96:99] offset:25088
    ds_write_b128 v16, v[100:103] offset:25104
    ds_write_b128 v16, v[104:107] offset:25120
    ds_write_b128 v16, v[108:111] offset:25136
    ds_write_b128 v16, v[112:115] offset:25152
    ds_write_b128 v16, v[116:119] offset:25168
    ds_write_b128 v16, v[120:123] offset:25184
    ds_write_b128 v16, v[124:127] offset:25200
    s_mov_b64 exec, 1
    ds_add_u32 v3, v4 offset:12
    s_mov_b64 exec, -1
    s_cmp_ge_u32 s3, 2
    s_cbranch_scc1 L_tailG
L_tailM:
    s_nop 1
    s_add_u32 s84, s97, 32768
    s_mov_b32 s6, 3
    s_mov_b32 s7, 3
    buffer_store_dwordx4 a[128:131], v76, s[64:67], s97 offen sc1
    buffer_store_dwordx4 a[132:135], v76, s[64:67], s84 offen sc1
    s_mov_b64 exec, s[6:7]
    buffer_store_dwordx2 a[136:137], v77, s[64:67], s60 offen sc1
    s_mov_b64 exec, -1
    s_waitcnt lgkmcnt(0)
L_aw_b:
    ds_read_b32 v7, v3 offset:12
    s_waitcnt lgkmcnt(0)
    v_readfirstlane_b32 s83, v7
    s_nop 0
    s_cmp_lt_u32 s83, 4
    s_cbranch_scc1 L_aw_b
    ds_read_b128 v[112:115], v19 offset:5376
    ds_read_b128 v[116:119], v19 offset:5392
    ds_read_b128 v[144:147], v19 offset:5440
    ds_read_b128 v[148:151], v19 offset:5456
    ds_read_b128 v[96:99], v18 offset:25088
    ds_read_b128 v[100:103], v18 offset:29312
    ds_read_b128 v[104:107], v18 offset:33536
    ds_read_b128 v[108:111], v18 offset:37760
    ds_read_b128 v[128:131], v18 offset:26144
    ds_read_b128 v[132:135], v18 offset:30368
    ds_read_b128 v[136:139], v18 offset:34592
    ds_read_b128 v[140:143], v18 offset:38816
    s_add_u32 s83, s97, 1048576
    s_add_u32 s84, s83, 32768
    s_mov_b32 s6, 3
    s_mov_b32 s7, 3
    v_and_b32 v7, 1, v0
    v_cmp_ne_u32 vcc, 0, v7
    s_waitcnt lgkmcnt(8)
    v_max3_f32 v7, v112, v114, v116
    v_max_f32 v7, v7, v118
    v_mul_f32 v8, s93, v7
    v_mul_f32 v112, s93, v112
    v_mul_f32 v114, s93, v114
    v_mul_f32 v116, s93, v116
    v_mul_f32 v118, s93, v118
    v_sub_f32 v112, v112, v8
    v_sub_f32 v114, v114, v8
    v_sub_f32 v116, v116, v8
    v_sub_f32 v118, v118, v8
    v_exp_f32 v112, v112
    v_exp_f32 v114, v114
    v_exp_f32 v116, v116
    v_exp_f32 v118, v118
    v_max3_f32 v9, v144, v146, v148
    v_max_f32 v9, v9, v150
    v_mul_f32 v10, s93, v9
    v_mul_f32 v144, s93, v144
    v_mul_f32 v146, s93, v146
    v_mul_f32 v148, s93, v148
    v_mul_f32 v150, s93, v150
    v_sub_f32 v144, v144, v10
    v_sub_f32 v146, v146, v10
    v_sub_f32 v148, v148, v10
    v_sub_f32 v150, v150, v10
    v_exp_f32 v144, v144
    v_exp_f32 v146, v146
    v_exp_f32 v148, v148
    v_exp_f32 v150, v150
    s_waitcnt lgkmcnt(0)
    v_mul_f32 v96, v96, v112
    v_mul_f32 v97, v97, v112
    v_mul_f32 v98, v98, v112
    v_mul_f32 v99, v99, v112
    v_fmac_f32 v96, v100, v114
    v_fmac_f32 v97, v101, v114
    v_fmac_f32 v98, v102, v114
    v_fmac_f32 v99, v103, v114
    v_fmac_f32 v96, v104, v116
    v_fmac_f32 v97, v105, v116
    v_fmac_f32 v98, v106, v116
    v_fmac_f32 v99, v107, v116
    v_fmac_f32 v96, v108, v118
    v_fmac_f32 v97, v109, v118
    v_fmac_f32 v98, v110, v118
    v_fmac_f32 v99, v111, v118
    v_bfi_b32 v100, s95, v5, v96
    v_bfi_b32 v101, s95, v5, v97
    v_bfi_b32 v102, s95, v5, v98
    v_bfi_b32 v103, s95, v5, v99
    buffer_store_dwordx4 v[100:103], v76, s[64:67], s83 offen sc1
    v_mul_f32 v128, v128, v144
    v_mul_f32 v129, v129, v144
    v_mul_f32 v130, v130, v144
    v_mul_f32 v131, v131, v144
    v_fmac_f32 v128, v132, v146
    v_fmac_f32 v129, v133, v146
    v_fmac_f32 v130, v134, v146
    v_fmac_f32 v131, v135, v146
    v_fmac_f32 v128, v136, v148
    v_fmac_f32 v129, v137, v148
    v_fmac_f32 v130, v138, v148
    v_fmac_f32 v131, v139, v148
    v_fmac_f32 v128, v140, v150
    v_fmac_f32 v129, v141, v150
    v_fmac_f32 v130, v142, v150
    v_fmac_f32 v131, v143, v150
    v_bfi_b32 v132, s95, v5, v128
    v_bfi_b32 v133, s95, v5, v129
    v_bfi_b32 v134, s95, v5, v130
    v_bfi_b32 v135, s95, v5, v131
    buffer_store_dwordx4 v[132:135], v76, s[64:67], s84 offen sc1
    v_mul_f32 v8, v113, v112
    v_fmac_f32 v8, v115, v114
    v_fmac_f32 v8, v117, v116
    v_fmac_f32 v8, v119, v118
    v_mul_f32 v10, v145, v144
    v_fmac_f32 v10, v147, v146
    v_fmac_f32 v10, v149, v148
    v_fmac_f32 v10, v151, v150
    v_cndmask_b32 v104, v7, v9, vcc
    v_cndmask_b32 v105, v8, v10, vcc
    v_bfi_b32 v104, s95, v5, v104
    v_bfi_b32 v105, s95, v5, v105
    s_mov_b64 exec, s[6:7]
    buffer_store_dwordx2 v[104:105], v78, s[64:67], s61 offen sc1
    s_mov_b64 exec, -1
    s_mov_b64 exec, 1
    ds_add_rtn_u32 v9, v3, v4 offset:28
    s_mov_b64 exec, -1
    s_lshr_b32 s84, s2, 5
    s_lshl_b32 s84, s84, 12
    s_add_u32 s84, s84, 393216
    s_waitcnt lgkmcnt(0)
    v_readfirstlane_b32 s83, v9
    s_nop 0
    s_cmp_lg_u32 s83, 1
    s_cbranch_scc1 L_nosig
    s_mov_b32 s35, 1
    s_atomic_add s35, s[64:65], s84
    s_add_u32 s84, s84, 256
    s_atomic_add s35, s[64:65], s84
    s_add_u32 s84, s84, 256
    s_atomic_add s35, s[64:65], s84
    s_add_u32 s84, s84, 256
    s_atomic_add s35, s[64:65], s84
    s_add_u32 s84, s84, 256
    s_atomic_add s35, s[64:65], s84
    s_add_u32 s84, s84, 256
    s_atomic_add s35, s[64:65], s84
    s_add_u32 s84, s84, 256
    s_atomic_add s35, s[64:65], s84
    s_add_u32 s84, s84, 256
    s_atomic_add s35, s[64:65], s84
L_nosig:
    s_add_u32 s83, s88, 0
    buffer_load_dwordx4 v[224:227], v2, s[56:59], s83 offen offset:256 nt
    s_add_u32 s83, s88, 16384
    buffer_load_dwordx4 v[228:231], v2, s[56:59], s83 offen offset:256 nt
    s_add_u32 s83, s88, 32768
    buffer_load_dwordx4 v[232:235], v2, s[56:59], s83 offen offset:256 nt
    s_add_u32 s83, s88, 49152
    buffer_load_dwordx4 v[236:239], v2, s[56:59], s83 offen offset:256 nt
    s_add_u32 s83, s88, 2048
    buffer_load_dwordx4 v[240:243], v2, s[56:59], s83 offen offset:256 nt
    s_add_u32 s83, s88, 18432
    buffer_load_dwordx4 v[244:247], v2, s[56:59], s83 offen offset:256 nt
    s_add_u32 s83, s88, 34816
    buffer_load_dwordx4 v[248:251], v2, s[56:59], s83 offen offset:256 nt
    s_add_u32 s83, s88, 51200
    buffer_load_dwordx4 v[252:255], v2, s[56:59], s83 offen offset:256 nt
    s_bfe_u32 s83, s2, 0x10006
    s_lshl_b32 s83, s83, 11
    v_lshlrev_b32 v7, 5, v0
    buffer_load_dwordx4 v[160:163], v7, s[68:71], s83 offen offset:0
    buffer_load_dwordx4 v[168:171], v7, s[72:75], 0 offen offset:0
    buffer_load_dwordx4 v[164:167], v7, s[68:71], s83 offen offset:16
    buffer_load_dwordx4 v[172:175], v7, s[72:75], 0 offen offset:16
    s_and_b32 s84, s3, 1
    s_lshl_b32 s84, s84, 2
    s_add_u32 s84, s84, s81
    s_lshl_b32 s84, s84, 4
    s_and_b32 s85, s2, 7
    s_add_u32 s84, s84, s85
    s_lshl_b32 s84, s84, 8
    s_add_u32 s85, s84, 393216
    s_waitcnt vmcnt(18)
    v_perm_b32 v36, v196, v192, s91
    v_perm_b32 v40, v196, v192, s92
    v_perm_b32 v37, v204, v200, s91
    v_perm_b32 v41, v204, v200, s92
    v_perm_b32 v38, v212, v208, s91
    v_perm_b32 v42, v212, v208, s92
    v_perm_b32 v39, v220, v216, s91
    v_perm_b32 v43, v220, v216, s92
    v_accvgpr_write_b32 a192, v36
    v_accvgpr_write_b32 a193, v37
    v_accvgpr_write_b32 a194, v38
    v_accvgpr_write_b32 a195, v39
    v_accvgpr_write_b32 a196, v40
    v_accvgpr_write_b32 a197, v41
    v_accvgpr_write_b32 a198, v42
    v_accvgpr_write_b32 a199, v43
    v_perm_b32 v44, v197, v193, s91
    v_perm_b32 v48, v197, v193, s92
    v_perm_b32 v45, v205, v201, s91
    v_perm_b32 v49, v205, v201, s92
    v_perm_b32 v46, v213, v209, s91
    v_perm_b32 v50, v213, v209, s92
    v_perm_b32 v47, v221, v217, s91
    v_perm_b32 v51, v221, v217, s92
    v_accvgpr_write_b32 a200, v44
    v_accvgpr_write_b32 a201, v45
    v_accvgpr_write_b32 a202, v46
    v_accvgpr_write_b32 a203, v47
    v_accvgpr_write_b32 a204, v48
    v_accvgpr_write_b32 a205, v49
    v_accvgpr_write_b32 a206, v50
    v_accvgpr_write_b32 a207, v51
    v_perm_b32 v36, v198, v194, s91
    v_perm_b32 v40, v198, v194, s92
    v_perm_b32 v37, v206, v202, s91
    v_perm_b32 v41, v206, v202, s92
    v_perm_b32 v38, v214, v210, s91
    v_perm_b32 v42, v214, v210, s92
    v_perm_b32 v39, v222, v218, s91
    v_perm_b32 v43, v222, v218, s92
    v_accvgpr_write_b32 a208, v36
    v_accvgpr_write_b32 a209, v37
    v_accvgpr_write_b32 a210, v38
    v_accvgpr_write_b32 a211, v39
    v_accvgpr_write_b32 a212, v40
    v_accvgpr_write_b32 a213, v41
    v_accvgpr_write_b32 a214, v42
    v_accvgpr_write_b32 a215, v43
    v_perm_b32 v44, v199, v195, s91
    v_perm_b32 v48, v199, v195, s92
    v_perm_b32 v45, v207, v203, s91
    v_perm_b32 v49, v207, v203, s92
    v_perm_b32 v46, v215, v211, s91
    v_perm_b32 v50, v215, v211, s92
    v_perm_b32 v47, v223, v219, s91
    v_perm_b32 v51, v223, v219, s92
    v_accvgpr_write_b32 a216, v44
    v_accvgpr_write_b32 a217, v45
    v_accvgpr_write_b32 a218, v46
    v_accvgpr_write_b32 a219, v47
    v_accvgpr_write_b32 a220, v48
    v_accvgpr_write_b32 a221, v49
    v_accvgpr_write_b32 a222, v50
    v_accvgpr_write_b32 a223, v51
    s_mov_b32 s100, 16384
L_ap_m:
    s_mov_b32 s40, 0
    s_atomic_add s40, s[64:65], s85 glc
    s_waitcnt lgkmcnt(0)
    s_cmp_ge_u32 s40, 32
    s_cbranch_scc1 L_apd_m
    s_sub_u32 s100, s100, 1
    s_cbranch_scc0 L_ap_m
L_apd_m:
    buffer_load_dwordx4 v[68:71], v79, s[64:67], s63 offen offset:0 sc1
    buffer_load_dwordx4 v[72:75], v79, s[64:67], s63 offen offset:16 sc1
    buffer_load_dwordx4 v[52:55], v1, s[64:67], s62 offen offset:0 sc1
    buffer_load_dwordx4 v[56:59], v1, s[64:67], s62 offen offset:1024 sc1
    buffer_load_dwordx4 v[60:63], v1, s[64:67], s62 offen offset:2048 sc1
    buffer_load_dwordx4 v[64:67], v1, s[64:67], s62 offen offset:3072 sc1
    s_waitcnt vmcnt(10)
    v_perm_b32 v36, v228, v224, s91
    v_perm_b32 v40, v228, v224, s92
    v_perm_b32 v37, v236, v232, s91
    v_perm_b32 v41, v236, v232, s92
    v_perm_b32 v38, v244, v240, s91
    v_perm_b32 v42, v244, v240, s92
    v_perm_b32 v39, v252, v248, s91
    v_perm_b32 v43, v252, v248, s92
    v_accvgpr_write_b32 a224, v36
    v_accvgpr_write_b32 a225, v37
    v_accvgpr_write_b32 a226, v38
    v_accvgpr_write_b32 a227, v39
    v_accvgpr_write_b32 a228, v40
    v_accvgpr_write_b32 a229, v41
    v_accvgpr_write_b32 a230, v42
    v_accvgpr_write_b32 a231, v43
    v_perm_b32 v44, v229, v225, s91
    v_perm_b32 v48, v229, v225, s92
    v_perm_b32 v45, v237, v233, s91
    v_perm_b32 v49, v237, v233, s92
    v_perm_b32 v46, v245, v241, s91
    v_perm_b32 v50, v245, v241, s92
    v_perm_b32 v47, v253, v249, s91
    v_perm_b32 v51, v253, v249, s92
    v_accvgpr_write_b32 a232, v44
    v_accvgpr_write_b32 a233, v45
    v_accvgpr_write_b32 a234, v46
    v_accvgpr_write_b32 a235, v47
    v_accvgpr_write_b32 a236, v48
    v_accvgpr_write_b32 a237, v49
    v_accvgpr_write_b32 a238, v50
    v_accvgpr_write_b32 a239, v51
    v_perm_b32 v36, v230, v226, s91
    v_perm_b32 v40, v230, v226, s92
    v_perm_b32 v37, v238, v234, s91
    v_perm_b32 v41, v238, v234, s92
    v_perm_b32 v38, v246, v242, s91
    v_perm_b32 v42, v246, v242, s92
    v_perm_b32 v39, v254, v250, s91
    v_perm_b32 v43, v254, v250, s92
    v_accvgpr_write_b32 a240, v36
    v_accvgpr_write_b32 a241, v37
    v_accvgpr_write_b32 a242, v38
    v_accvgpr_write_b32 a243, v39
    v_accvgpr_write_b32 a244, v40
    v_accvgpr_write_b32 a245, v41
    v_accvgpr_write_b32 a246, v42
    v_accvgpr_write_b32 a247, v43
    v_perm_b32 v44, v231, v227, s91
    v_perm_b32 v48, v231, v227, s92
    v_perm_b32 v45, v239, v235, s91
    v_perm_b32 v49, v239, v235, s92
    v_perm_b32 v46, v247, v243, s91
    v_perm_b32 v50, v247, v243, s92
    v_perm_b32 v47, v255, v251, s91
    v_perm_b32 v51, v255, v251, s92
    v_accvgpr_write_b32 a248, v44
    v_accvgpr_write_b32 a249, v45
    v_accvgpr_write_b32 a250, v46
    v_accvgpr_write_b32 a251, v47
    v_accvgpr_write_b32 a252, v48
    v_accvgpr_write_b32 a253, v49
    v_accvgpr_write_b32 a254, v50
    v_accvgpr_write_b32 a255, v51
    s_waitcnt vmcnt(0)
    s_mov_b32 s100, 16384
    s_nop 1
L_chk_a:
    v_xor_b32 v52, s89, v52
    v_xor_b32 v53, s89, v53
    v_xor_b32 v54, s89, v54
    v_xor_b32 v55, s89, v55
    v_xor_b32 v56, s89, v56
    v_xor_b32 v57, s89, v57
    v_xor_b32 v58, s89, v58
    v_xor_b32 v59, s89, v59
    v_xor_b32 v60, s89, v60
    v_xor_b32 v61, s89, v61
    v_xor_b32 v62, s89, v62
    v_xor_b32 v63, s89, v63
    v_xor_b32 v64, s89, v64
    v_xor_b32 v65, s89, v65
    v_xor_b32 v66, s89, v66
    v_xor_b32 v67, s89, v67
    v_xor_b32 v68, s89, v68
    v_xor_b32 v69, s89, v69
    v_xor_b32 v70, s89, v70
    v_xor_b32 v71, s89, v71
    v_xor_b32 v72, s89, v72
    v_xor_b32 v73, s89, v73
    v_xor_b32 v74, s89, v74
    v_xor_b32 v75, s89, v75
    v_or_b32 v7, v52, v53
    v_or3_b32 v7, v7, v54, v55
    v_or3_b32 v7, v7, v56, v57
    v_or3_b32 v7, v7, v58, v59
    v_or3_b32 v7, v7, v60, v61
    v_or3_b32 v7, v7, v62, v63
    v_or3_b32 v7, v7, v64, v65
    v_or3_b32 v7, v7, v66, v67
    v_or3_b32 v7, v7, v68, v69
    v_or3_b32 v7, v7, v70, v71
    v_or3_b32 v7, v7, v72, v73
    v_or3_b32 v7, v7, v74, v75
    v_and_b32 v7, 4095, v7
    v_cmp_ne_u32 vcc, 0, v7
    s_nop 4
    s_cbranch_vccz L_ok_a
    s_sub_u32 s100, s100, 1
    s_cbranch_scc1 L_ok_a
    s_mov_b64 exec, vcc
    buffer_load_dwordx4 v[68:71], v79, s[64:67], s63 offen offset:0 sc1
    buffer_load_dwordx4 v[72:75], v79, s[64:67], s63 offen offset:16 sc1
    buffer_load_dwordx4 v[52:55], v1, s[64:67], s62 offen offset:0 sc1
    buffer_load_dwordx4 v[56:59], v1, s[64:67], s62 offen offset:1024 sc1
    buffer_load_dwordx4 v[60:63], v1, s[64:67], s62 offen offset:2048 sc1
    buffer_load_dwordx4 v[64:67], v1, s[64:67], s62 offen offset:3072 sc1
    s_waitcnt vmcnt(0)
    s_branch L_chk_a
L_ok_a:
    s_mov_b64 exec, -1
    v_max3_f32 v20, v68, v70, v72
    v_max_f32 v20, v20, v74
    v_mul_f32 v68, s93, v68
    v_mul_f32 v70, s93, v70
    v_mul_f32 v72, s93, v72
    v_mul_f32 v74, s93, v74
    v_max_f32_dpp v20, v20, v20 row_ror:8 row_mask:0xf bank_mask:0xf
    v_mov_b32 v22, v20
    s_nop 1
    v_permlane16_swap_b32 v20, v22
    v_max_f32 v20, v20, v22
    v_mov_b32 v22, v20
    s_nop 1
    v_permlane32_swap_b32 v20, v22
    v_max_f32 v20, v20, v22
    v_mul_f32 v20, s93, v20
    v_sub_f32 v68, v68, v20
    v_sub_f32 v70, v70, v20
    v_sub_f32 v72, v72, v20
    v_sub_f32 v74, v74, v20
    v_exp_f32 v68, v68
    v_exp_f32 v70, v70
    v_exp_f32 v72, v72
    v_exp_f32 v74, v74
    v_mul_f32 v52, v52, v68
    v_mul_f32 v53, v53, v68
    v_mul_f32 v54, v54, v68
    v_mul_f32 v55, v55, v68
    v_mul_f32 v21, v69, v68
    v_fmac_f32 v52, v56, v70
    v_fmac_f32 v53, v57, v70
    v_fmac_f32 v54, v58, v70
    v_fmac_f32 v55, v59, v70
    v_fmac_f32 v21, v71, v70
    v_fmac_f32 v52, v60, v72
    v_fmac_f32 v53, v61, v72
    v_fmac_f32 v54, v62, v72
    v_fmac_f32 v55, v63, v72
    v_fmac_f32 v21, v73, v72
    v_fmac_f32 v52, v64, v74
    v_fmac_f32 v53, v65, v74
    v_fmac_f32 v54, v66, v74
    v_fmac_f32 v55, v67, v74
    v_fmac_f32 v21, v75, v74
    v_mov_b32 v22, v21
    v_permlane32_swap_b32 v52, v53
    v_permlane32_swap_b32 v54, v55
    v_permlane32_swap_b32 v21, v22
    v_add_f32 v52, v52, v53
    v_add_f32 v21, v21, v22
    v_add_f32 v54, v54, v55
    v_mov_b32 v22, v21
    s_mov_b32 s6, 0x00ff00ff
    s_mov_b32 s7, 0x00ff00ff
    v_permlane16_swap_b32 v52, v54
    v_permlane16_swap_b32 v21, v22
    v_add_f32 v52, v52, v54
    v_add_f32 v21, v21, v22
    s_nop 1
    v_add_f32_dpp v21, v21, v21 row_ror:8 row_mask:0xf bank_mask:0xf
    v_add_f32_dpp v52, v52, v52 row_ror:8 row_mask:0xf bank_mask:0xf
    v_rcp_f32 v21, v21
    s_nop 0
    v_mul_f32 v52, v52, v21
    v_cvt_pk_bf16_f32 v52, v52, v52
    s_mov_b64 exec, s[6:7]
    ds_write_b16 v80, v52 offset:4608
    s_mov_b64 exec, 1
    ds_add_u32 v3, v4 offset:16
    s_mov_b64 exec, -1
    s_mov_b64 exec, 1
    ds_add_rtn_u32 v9, v3, v4 offset:32
    s_mov_b64 exec, -1
    v_and_b32 v8, 16, v0
    v_cmp_ne_u32 vcc, 0, v8
    s_add_u32 s84, s94, 131072
    s_waitcnt lgkmcnt(0)
L_aw_oa:
    ds_read_b32 v7, v3 offset:16
    ds_read_b128 v[32:35], v82 offset:4608
    s_waitcnt lgkmcnt(0)
    v_readfirstlane_b32 s83, v7
    s_nop 0
    s_cmp_lt_u32 s83, 2
    s_cbranch_scc1 L_aw_oa
    v_mfma_f32_16x16x32_bf16 v[192:195], v[32:35], a[192:195], 0
    v_mfma_f32_16x16x32_bf16 v[208:211], v[32:35], a[208:211], 0
    v_mfma_f32_16x16x32_bf16 v[196:199], v[32:35], a[196:199], 0
    v_mfma_f32_16x16x32_bf16 v[212:215], v[32:35], a[212:215], 0
    v_mfma_f32_16x16x32_bf16 v[200:203], v[32:35], a[200:203], 0
    v_mfma_f32_16x16x32_bf16 v[216:219], v[32:35], a[216:219], 0
    v_mfma_f32_16x16x32_bf16 v[204:207], v[32:35], a[204:207], 0
    v_mfma_f32_16x16x32_bf16 v[220:223], v[32:35], a[220:223], 0
    v_readfirstlane_b32 s83, v9
    s_lshr_b32 s34, s82, 4
    s_lshl_b32 s34, s34, 2
    s_add_u32 s34, s34, s81
    s_lshl_b32 s34, s34, 12
    s_add_u32 s34, s34, 425984
    s_mov_b32 s35, 1
    s_cmp_lg_u32 s83, 3
    s_cbranch_scc1 L_nofireoa
    s_atomic_add s35, s[64:65], s34
    s_add_u32 s34, s34, 256
    s_atomic_add s35, s[64:65], s34
    s_add_u32 s34, s34, 256
    s_atomic_add s35, s[64:65], s34
    s_add_u32 s34, s34, 256
    s_atomic_add s35, s[64:65], s34
    s_add_u32 s34, s34, 256
    s_atomic_add s35, s[64:65], s34
    s_add_u32 s34, s34, 256
    s_atomic_add s35, s[64:65], s34
    s_add_u32 s34, s34, 256
    s_atomic_add s35, s[64:65], s34
    s_add_u32 s34, s34, 256
    s_atomic_add s35, s[64:65], s34
L_nofireoa:
    v_mfma_f32_16x16x32_bf16 v[224:227], v[32:35], a[224:227], 0
    v_mfma_f32_16x16x32_bf16 v[240:243], v[32:35], a[240:243], 0
    v_mfma_f32_16x16x32_bf16 v[228:231], v[32:35], a[228:231], 0
    v_mfma_f32_16x16x32_bf16 v[244:247], v[32:35], a[244:247], 0
    v_mfma_f32_16x16x32_bf16 v[232:235], v[32:35], a[232:235], 0
    v_mfma_f32_16x16x32_bf16 v[248:251], v[32:35], a[248:251], 0
    v_mfma_f32_16x16x32_bf16 v[236:239], v[32:35], a[236:239], 0
    v_mfma_f32_16x16x32_bf16 v[252:255], v[32:35], a[252:255], 0
    v_cndmask_b32 v36, v192, v208, vcc
    v_cndmask_b32 v37, v196, v212, vcc
    v_cndmask_b32 v38, v200, v216, vcc
    v_cndmask_b32 v39, v204, v220, vcc
    v_bfi_b32 v36, s95, v5, v36
    v_bfi_b32 v37, s95, v5, v37
    v_bfi_b32 v38, s95, v5, v38
    v_bfi_b32 v39, s95, v5, v39
    buffer_store_dwordx4 v[36:39], v81, s[64:67], s94 offen sc1
    v_cndmask_b32 v40, v224, v240, vcc
    v_cndmask_b32 v41, v228, v244, vcc
    v_cndmask_b32 v42, v232, v248, vcc
    v_cndmask_b32 v43, v236, v252, vcc
    v_bfi_b32 v40, s95, v5, v40
    v_bfi_b32 v41, s95, v5, v41
    v_bfi_b32 v42, s95, v5, v42
    v_bfi_b32 v43, s95, v5, v43
    buffer_store_dwordx4 v[40:43], v81, s[64:67], s84 offen sc1
    s_cmp_lg_u32 s96, 0
    s_cbranch_scc1 L_fin
    s_lshl_b32 s97, s2, 14
    s_add_u32 s97, s97, 4194304
    s_lshl_b32 s83, s3, 13
    s_add_u32 s97, s97, s83
    s_bfe_u32 s84, s2, 0x10005
    s_lshl_b32 s84, s84, 6
    s_and_b32 s85, s2, 7
    s_add_u32 s84, s84, s85
    s_lshl_b32 s84, s84, 8
    s_add_u32 s85, s84, 425984
    s_add_u32 s86, s85, 4096
    s_add_u32 s87, s85, 8192
    s_add_u32 s52, s85, 12288
    v_mov_b32 v7, 0
    s_mov_b32 s83, 0x3f803f80
    v_mov_b32 v10, s83
    v_lshlrev_b32 v20, 16, v160
    v_and_b32 v21, s98, v160
    v_lshlrev_b32 v22, 16, v168
    v_and_b32 v23, s98, v168
    v_mul_f32 v20, v20, v22
    v_mul_f32 v21, v21, v23
    v_cvt_pk_bf16_f32 v24, v20, v21
    v_dot2c_f32_bf16 v7, v24, v10
    v_lshlrev_b32 v20, 16, v161
    v_and_b32 v21, s98, v161
    v_lshlrev_b32 v22, 16, v169
    v_and_b32 v23, s98, v169
    v_mul_f32 v20, v20, v22
    v_mul_f32 v21, v21, v23
    v_cvt_pk_bf16_f32 v24, v20, v21
    v_dot2c_f32_bf16 v7, v24, v10
    v_lshlrev_b32 v20, 16, v162
    v_and_b32 v21, s98, v162
    v_lshlrev_b32 v22, 16, v170
    v_and_b32 v23, s98, v170
    v_mul_f32 v20, v20, v22
    v_mul_f32 v21, v21, v23
    v_cvt_pk_bf16_f32 v24, v20, v21
    v_dot2c_f32_bf16 v7, v24, v10
    v_lshlrev_b32 v20, 16, v163
    v_and_b32 v21, s98, v163
    v_lshlrev_b32 v22, 16, v171
    v_and_b32 v23, s98, v171
    v_mul_f32 v20, v20, v22
    v_mul_f32 v21, v21, v23
    v_cvt_pk_bf16_f32 v24, v20, v21
    v_dot2c_f32_bf16 v7, v24, v10
    v_lshlrev_b32 v20, 16, v164
    v_and_b32 v21, s98, v164
    v_lshlrev_b32 v22, 16, v172
    v_and_b32 v23, s98, v172
    v_mul_f32 v20, v20, v22
    v_mul_f32 v21, v21, v23
    v_cvt_pk_bf16_f32 v24, v20, v21
    v_dot2c_f32_bf16 v7, v24, v10
    v_lshlrev_b32 v20, 16, v165
    v_and_b32 v21, s98, v165
    v_lshlrev_b32 v22, 16, v173
    v_and_b32 v23, s98, v173
    v_mul_f32 v20, v20, v22
    v_mul_f32 v21, v21, v23
    v_cvt_pk_bf16_f32 v24, v20, v21
    v_dot2c_f32_bf16 v7, v24, v10
    v_lshlrev_b32 v20, 16, v166
    v_and_b32 v21, s98, v166
    v_lshlrev_b32 v22, 16, v174
    v_and_b32 v23, s98, v174
    v_mul_f32 v20, v20, v22
    v_mul_f32 v21, v21, v23
    v_cvt_pk_bf16_f32 v24, v20, v21
    v_dot2c_f32_bf16 v7, v24, v10
    v_lshlrev_b32 v20, 16, v167
    v_and_b32 v21, s98, v167
    v_lshlrev_b32 v22, 16, v175
    v_and_b32 v23, s98, v175
    v_mul_f32 v20, v20, v22
    v_mul_f32 v21, v21, v23
    v_cvt_pk_bf16_f32 v24, v20, v21
    v_dot2c_f32_bf16 v7, v24, v10
    s_nop 2
    v_add_f32_dpp v7, v7, v7 quad_perm:[1,0,3,2] row_mask:0xf bank_mask:0xf
    s_nop 1
    v_add_f32_dpp v7, v7, v7 quad_perm:[2,3,0,1] row_mask:0xf bank_mask:0xf
    s_nop 1
    v_add_f32_dpp v7, v7, v7 row_ror:4 row_mask:0xf bank_mask:0xf
    s_nop 1
    v_add_f32_dpp v7, v7, v7 row_ror:8 row_mask:0xf bank_mask:0xf
    v_mov_b32 v8, v7
    s_nop 1
    v_permlane16_swap_b32 v7, v8
    v_add_f32 v7, v7, v8
    v_mov_b32 v8, v7
    s_nop 1
    v_permlane32_swap_b32 v7, v8
    v_add_f32 v7, v7, v8
    v_cvt_pk_bf16_f32 v7, v7, v7
    v_and_b32 v7, s98, v7
    v_mul_f32 v7, s93, v7
    v_exp_f32 v7, -v7
    s_nop 0
    v_add_f32 v7, 1.0, v7
    v_rcp_f32 v7, v7
    s_nop 0
    v_cvt_pk_bf16_f32 v7, v7, v7
    v_and_b32 v7, s98, v7
    v_sub_f32 v8, 1.0, v7
    v_cvt_pk_bf16_f32 v8, v8, v8
    v_and_b32 v8, s98, v8
    v_readfirstlane_b32 s72, v7
    v_readfirstlane_b32 s73, v8
    s_nop 3
    s_cmp_eq_u32 s3, 0
    s_cselect_b32 s72, s72, s73
    s_mov_b32 s100, 16384
L_ap_f:
    s_mov_b32 s40, 0
    s_atomic_add s40, s[64:65], s85 glc
    s_mov_b32 s41, 0
    s_atomic_add s41, s[64:65], s86 glc
    s_mov_b32 s42, 0
    s_atomic_add s42, s[64:65], s87 glc
    s_mov_b32 s43, 0
    s_atomic_add s43, s[64:65], s52 glc
    s_waitcnt lgkmcnt(0)
    s_min_u32 s40, s40, s43
    s_min_u32 s40, s40, s42
    s_min_u32 s40, s40, s41
    s_cmp_ge_u32 s40, 32
    s_cbranch_scc1 L_apd_f
    s_sub_u32 s100, s100, 1
    s_cbranch_scc0 L_ap_f
L_apd_f:
    s_add_u32 s83, s97, 0
    buffer_load_dwordx4 v[192:195], v1, s[64:67], s83 offen offset:0 sc1
    buffer_load_dwordx4 v[196:199], v1, s[64:67], s83 offen offset:1024 sc1
    buffer_load_dwordx4 v[200:203], v1, s[64:67], s83 offen offset:2048 sc1
    buffer_load_dwordx4 v[204:207], v1, s[64:67], s83 offen offset:3072 sc1
    s_add_u32 s83, s97, 4096
    buffer_load_dwordx4 v[208:211], v1, s[64:67], s83 offen offset:0 sc1
    buffer_load_dwordx4 v[212:215], v1, s[64:67], s83 offen offset:1024 sc1
    buffer_load_dwordx4 v[216:219], v1, s[64:67], s83 offen offset:2048 sc1
    buffer_load_dwordx4 v[220:223], v1, s[64:67], s83 offen offset:3072 sc1
    v_lshlrev_b32 v10, 3, v0
    v_lshlrev_b32 v9, 4, v0
    v_and_b32 v10, 3, v0
    v_lshl_add_u32 v10, v10, 3, v87
    v_lshlrev_b32 v9, 2, v0
    s_waitcnt vmcnt(0)
    s_mov_b32 s100, 16384
    s_nop 1
L_chk_f:
    v_xor_b32 v192, s89, v192
    v_xor_b32 v193, s89, v193
    v_xor_b32 v194, s89, v194
    v_xor_b32 v195, s89, v195
    v_xor_b32 v196, s89, v196
    v_xor_b32 v197, s89, v197
    v_xor_b32 v198, s89, v198
    v_xor_b32 v199, s89, v199
    v_xor_b32 v200, s89, v200
    v_xor_b32 v201, s89, v201
    v_xor_b32 v202, s89, v202
    v_xor_b32 v203, s89, v203
    v_xor_b32 v204, s89, v204
    v_xor_b32 v205, s89, v205
    v_xor_b32 v206, s89, v206
    v_xor_b32 v207, s89, v207
    v_xor_b32 v208, s89, v208
    v_xor_b32 v209, s89, v209
    v_xor_b32 v210, s89, v210
    v_xor_b32 v211, s89, v211
    v_xor_b32 v212, s89, v212
    v_xor_b32 v213, s89, v213
    v_xor_b32 v214, s89, v214
    v_xor_b32 v215, s89, v215
    v_xor_b32 v216, s89, v216
    v_xor_b32 v217, s89, v217
    v_xor_b32 v218, s89, v218
    v_xor_b32 v219, s89, v219
    v_xor_b32 v220, s89, v220
    v_xor_b32 v221, s89, v221
    v_xor_b32 v222, s89, v222
    v_xor_b32 v223, s89, v223
    v_or_b32 v7, v192, v193
    v_or3_b32 v7, v7, v194, v195
    v_or3_b32 v7, v7, v196, v197
    v_or3_b32 v7, v7, v198, v199
    v_or3_b32 v7, v7, v200, v201
    v_or3_b32 v7, v7, v202, v203
    v_or3_b32 v7, v7, v204, v205
    v_or3_b32 v7, v7, v206, v207
    v_or3_b32 v7, v7, v208, v209
    v_or3_b32 v7, v7, v210, v211
    v_or3_b32 v7, v7, v212, v213
    v_or3_b32 v7, v7, v214, v215
    v_or3_b32 v7, v7, v216, v217
    v_or3_b32 v7, v7, v218, v219
    v_or3_b32 v7, v7, v220, v221
    v_or3_b32 v7, v7, v222, v223
    v_and_b32 v7, 4095, v7
    v_cmp_ne_u32 vcc, 0, v7
    s_nop 4
    s_cbranch_vccz L_ok_f
    s_sub_u32 s100, s100, 1
    s_cbranch_scc1 L_ok_f
    s_mov_b64 exec, vcc
    s_add_u32 s83, s97, 0
    buffer_load_dwordx4 v[192:195], v1, s[64:67], s83 offen offset:0 sc1
    buffer_load_dwordx4 v[196:199], v1, s[64:67], s83 offen offset:1024 sc1
    buffer_load_dwordx4 v[200:203], v1, s[64:67], s83 offen offset:2048 sc1
    buffer_load_dwordx4 v[204:207], v1, s[64:67], s83 offen offset:3072 sc1
    s_add_u32 s83, s97, 4096
    buffer_load_dwordx4 v[208:211], v1, s[64:67], s83 offen offset:0 sc1
    buffer_load_dwordx4 v[212:215], v1, s[64:67], s83 offen offset:1024 sc1
    buffer_load_dwordx4 v[216:219], v1, s[64:67], s83 offen offset:2048 sc1
    buffer_load_dwordx4 v[220:223], v1, s[64:67], s83 offen offset:3072 sc1
    s_waitcnt vmcnt(0)
    s_branch L_chk_f
L_ok_f:
    s_mov_b64 exec, -1
    v_add_f32 v192, v192, v208
    v_add_f32 v193, v193, v209
    v_add_f32 v194, v194, v210
    v_add_f32 v195, v195, v211
    v_add_f32 v196, v196, v212
    v_add_f32 v197, v197, v213
    v_add_f32 v198, v198, v214
    v_add_f32 v199, v199, v215
    v_add_f32 v200, v200, v216
    v_add_f32 v201, v201, v217
    v_add_f32 v202, v202, v218
    v_add_f32 v203, v203, v219
    v_add_f32 v204, v204, v220
    v_add_f32 v205, v205, v221
    v_add_f32 v206, v206, v222
    v_add_f32 v207, v207, v223
    v_add_f32 v192, v192, v200
    v_add_f32 v193, v193, v201
    v_add_f32 v194, v194, v202
    v_add_f32 v195, v195, v203
    v_add_f32 v196, v196, v204
    v_add_f32 v197, v197, v205
    v_add_f32 v198, v198, v206
    v_add_f32 v199, v199, v207
    v_add_f32 v192, v192, v196
    v_add_f32 v193, v193, v197
    v_add_f32 v194, v194, v198
    v_add_f32 v195, v195, v199
    s_mov_b32 s6, 0x000f000f
    s_mov_b32 s7, 0x000f000f
    v_permlane32_swap_b32 v192, v193
    v_permlane32_swap_b32 v194, v195
    v_add_f32 v192, v192, v193
    v_add_f32 v194, v194, v195
    s_nop 1
    v_permlane16_swap_b32 v192, v194
    v_add_f32 v192, v192, v194
    s_nop 1
    v_add_f32_dpp v192, v192, v192 row_ror:8 row_mask:0xf bank_mask:0xf
    s_nop 1
    v_add_f32_dpp v192, v192, v192 row_ror:4 row_mask:0xf bank_mask:0xf
    v_cvt_pk_bf16_f32 v192, v192, v192
    v_and_b32 v192, s98, v192
    v_mul_f32 v192, s72, v192
    v_cvt_pk_bf16_f32 v192, v192, v192
    v_and_b32 v192, s98, v192
    s_cmp_eq_u32 s3, 0
    s_cbranch_scc1 L_w0
    ds_write_b32 v9, v192 offset:5888
    s_mov_b64 exec, 1
    ds_add_u32 v3, v4 offset:36
    s_mov_b64 exec, -1
    s_branch L_fin
L_w0:
    s_lshl_b32 s84, s2, 5
L_aw_bt:
    ds_read_b32 v7, v3 offset:36
    ds_read_b32 v193, v9 offset:5888
    s_waitcnt lgkmcnt(0)
    v_readfirstlane_b32 s83, v7
    s_nop 0
    s_cmp_lt_u32 s83, 1
    s_cbranch_scc1 L_aw_bt
    v_add_f32 v192, v192, v193
    v_cvt_pk_bf16_f32 v192, v192, v192
    s_mov_b64 exec, s[6:7]
    buffer_store_short v192, v10, s[76:79], s84 offen
    s_mov_b64 exec, 1
    s_cmp_lg_u32 s2, 0
    s_cbranch_scc1 L_noe
    v_mov_b32 v8, s101
    buffer_store_dword v8, v6, s[64:67], 0 offen
L_noe:
    s_mov_b64 exec, -1
    s_branch L_fin
L_tailG:
    s_nop 1
    s_add_u32 s83, s88, 0
    buffer_load_dwordx4 v[224:227], v2, s[56:59], s83 offen offset:256 nt
    s_add_u32 s83, s88, 16384
    buffer_load_dwordx4 v[228:231], v2, s[56:59], s83 offen offset:256 nt
    s_add_u32 s83, s88, 32768
    buffer_load_dwordx4 v[232:235], v2, s[56:59], s83 offen offset:256 nt
    s_add_u32 s83, s88, 49152
    buffer_load_dwordx4 v[236:239], v2, s[56:59], s83 offen offset:256 nt
    s_add_u32 s83, s88, 2048
    buffer_load_dwordx4 v[240:243], v2, s[56:59], s83 offen offset:256 nt
    s_add_u32 s83, s88, 18432
    buffer_load_dwordx4 v[244:247], v2, s[56:59], s83 offen offset:256 nt
    s_add_u32 s83, s88, 34816
    buffer_load_dwordx4 v[248:251], v2, s[56:59], s83 offen offset:256 nt
    s_add_u32 s83, s88, 51200
    buffer_load_dwordx4 v[252:255], v2, s[56:59], s83 offen offset:256 nt
    s_and_b32 s84, s3, 1
    s_lshl_b32 s84, s84, 2
    s_add_u32 s84, s84, s81
    s_lshl_b32 s84, s84, 4
    s_and_b32 s85, s2, 7
    s_add_u32 s84, s84, s85
    s_lshl_b32 s84, s84, 8
    s_add_u32 s85, s84, 393216
    s_waitcnt vmcnt(8)
    v_perm_b32 v36, v196, v192, s91
    v_perm_b32 v40, v196, v192, s92
    v_perm_b32 v37, v204, v200, s91
    v_perm_b32 v41, v204, v200, s92
    v_perm_b32 v38, v212, v208, s91
    v_perm_b32 v42, v212, v208, s92
    v_perm_b32 v39, v220, v216, s91
    v_perm_b32 v43, v220, v216, s92
    v_accvgpr_write_b32 a192, v36
    v_accvgpr_write_b32 a193, v37
    v_accvgpr_write_b32 a194, v38
    v_accvgpr_write_b32 a195, v39
    v_accvgpr_write_b32 a196, v40
    v_accvgpr_write_b32 a197, v41
    v_accvgpr_write_b32 a198, v42
    v_accvgpr_write_b32 a199, v43
    v_perm_b32 v44, v197, v193, s91
    v_perm_b32 v48, v197, v193, s92
    v_perm_b32 v45, v205, v201, s91
    v_perm_b32 v49, v205, v201, s92
    v_perm_b32 v46, v213, v209, s91
    v_perm_b32 v50, v213, v209, s92
    v_perm_b32 v47, v221, v217, s91
    v_perm_b32 v51, v221, v217, s92
    v_accvgpr_write_b32 a200, v44
    v_accvgpr_write_b32 a201, v45
    v_accvgpr_write_b32 a202, v46
    v_accvgpr_write_b32 a203, v47
    v_accvgpr_write_b32 a204, v48
    v_accvgpr_write_b32 a205, v49
    v_accvgpr_write_b32 a206, v50
    v_accvgpr_write_b32 a207, v51
    v_perm_b32 v36, v198, v194, s91
    v_perm_b32 v40, v198, v194, s92
    v_perm_b32 v37, v206, v202, s91
    v_perm_b32 v41, v206, v202, s92
    v_perm_b32 v38, v214, v210, s91
    v_perm_b32 v42, v214, v210, s92
    v_perm_b32 v39, v222, v218, s91
    v_perm_b32 v43, v222, v218, s92
    v_accvgpr_write_b32 a208, v36
    v_accvgpr_write_b32 a209, v37
    v_accvgpr_write_b32 a210, v38
    v_accvgpr_write_b32 a211, v39
    v_accvgpr_write_b32 a212, v40
    v_accvgpr_write_b32 a213, v41
    v_accvgpr_write_b32 a214, v42
    v_accvgpr_write_b32 a215, v43
    v_perm_b32 v44, v199, v195, s91
    v_perm_b32 v48, v199, v195, s92
    v_perm_b32 v45, v207, v203, s91
    v_perm_b32 v49, v207, v203, s92
    v_perm_b32 v46, v215, v211, s91
    v_perm_b32 v50, v215, v211, s92
    v_perm_b32 v47, v223, v219, s91
    v_perm_b32 v51, v223, v219, s92
    v_accvgpr_write_b32 a216, v44
    v_accvgpr_write_b32 a217, v45
    v_accvgpr_write_b32 a218, v46
    v_accvgpr_write_b32 a219, v47
    v_accvgpr_write_b32 a220, v48
    v_accvgpr_write_b32 a221, v49
    v_accvgpr_write_b32 a222, v50
    v_accvgpr_write_b32 a223, v51
    s_mov_b32 s100, 16384
L_ap_g:
    s_mov_b32 s40, 0
    s_atomic_add s40, s[64:65], s85 glc
    s_waitcnt lgkmcnt(0)
    s_cmp_ge_u32 s40, 32
    s_cbranch_scc1 L_apd_g
    s_sub_u32 s100, s100, 1
    s_cbranch_scc0 L_ap_g
L_apd_g:
    s_add_u32 s84, s63, 4096
    buffer_load_dwordx2 v[68:69], v79, s[64:67], s63 offen offset:0 sc1
    buffer_load_dwordx2 v[70:71], v79, s[64:67], s63 offen offset:2048 sc1
    buffer_load_dwordx2 v[72:73], v79, s[64:67], s84 offen offset:0 sc1
    buffer_load_dwordx2 v[74:75], v79, s[64:67], s84 offen offset:2048 sc1
    buffer_load_dwordx4 v[52:55], v1, s[64:67], s62 offen offset:0 sc1
    buffer_load_dwordx4 v[56:59], v1, s[64:67], s62 offen offset:1024 sc1
    buffer_load_dwordx4 v[60:63], v1, s[64:67], s62 offen offset:2048 sc1
    buffer_load_dwordx4 v[64:67], v1, s[64:67], s62 offen offset:3072 sc1
    s_waitcnt vmcnt(8)
    v_perm_b32 v36, v228, v224, s91
    v_perm_b32 v40, v228, v224, s92
    v_perm_b32 v37, v236, v232, s91
    v_perm_b32 v41, v236, v232, s92
    v_perm_b32 v38, v244, v240, s91
    v_perm_b32 v42, v244, v240, s92
    v_perm_b32 v39, v252, v248, s91
    v_perm_b32 v43, v252, v248, s92
    v_accvgpr_write_b32 a224, v36
    v_accvgpr_write_b32 a225, v37
    v_accvgpr_write_b32 a226, v38
    v_accvgpr_write_b32 a227, v39
    v_accvgpr_write_b32 a228, v40
    v_accvgpr_write_b32 a229, v41
    v_accvgpr_write_b32 a230, v42
    v_accvgpr_write_b32 a231, v43
    v_perm_b32 v44, v229, v225, s91
    v_perm_b32 v48, v229, v225, s92
    v_perm_b32 v45, v237, v233, s91
    v_perm_b32 v49, v237, v233, s92
    v_perm_b32 v46, v245, v241, s91
    v_perm_b32 v50, v245, v241, s92
    v_perm_b32 v47, v253, v249, s91
    v_perm_b32 v51, v253, v249, s92
    v_accvgpr_write_b32 a232, v44
    v_accvgpr_write_b32 a233, v45
    v_accvgpr_write_b32 a234, v46
    v_accvgpr_write_b32 a235, v47
    v_accvgpr_write_b32 a236, v48
    v_accvgpr_write_b32 a237, v49
    v_accvgpr_write_b32 a238, v50
    v_accvgpr_write_b32 a239, v51
    v_perm_b32 v36, v230, v226, s91
    v_perm_b32 v40, v230, v226, s92
    v_perm_b32 v37, v238, v234, s91
    v_perm_b32 v41, v238, v234, s92
    v_perm_b32 v38, v246, v242, s91
    v_perm_b32 v42, v246, v242, s92
    v_perm_b32 v39, v254, v250, s91
    v_perm_b32 v43, v254, v250, s92
    v_accvgpr_write_b32 a240, v36
    v_accvgpr_write_b32 a241, v37
    v_accvgpr_write_b32 a242, v38
    v_accvgpr_write_b32 a243, v39
    v_accvgpr_write_b32 a244, v40
    v_accvgpr_write_b32 a245, v41
    v_accvgpr_write_b32 a246, v42
    v_accvgpr_write_b32 a247, v43
    v_perm_b32 v44, v231, v227, s91
    v_perm_b32 v48, v231, v227, s92
    v_perm_b32 v45, v239, v235, s91
    v_perm_b32 v49, v239, v235, s92
    v_perm_b32 v46, v247, v243, s91
    v_perm_b32 v50, v247, v243, s92
    v_perm_b32 v47, v255, v251, s91
    v_perm_b32 v51, v255, v251, s92
    v_accvgpr_write_b32 a248, v44
    v_accvgpr_write_b32 a249, v45
    v_accvgpr_write_b32 a250, v46
    v_accvgpr_write_b32 a251, v47
    v_accvgpr_write_b32 a252, v48
    v_accvgpr_write_b32 a253, v49
    v_accvgpr_write_b32 a254, v50
    v_accvgpr_write_b32 a255, v51
    s_waitcnt vmcnt(0)
    s_mov_b32 s100, 16384
    s_nop 1
L_chk_b:
    v_xor_b32 v52, s89, v52
    v_xor_b32 v53, s89, v53
    v_xor_b32 v54, s89, v54
    v_xor_b32 v55, s89, v55
    v_xor_b32 v56, s89, v56
    v_xor_b32 v57, s89, v57
    v_xor_b32 v58, s89, v58
    v_xor_b32 v59, s89, v59
    v_xor_b32 v60, s89, v60
    v_xor_b32 v61, s89, v61
    v_xor_b32 v62, s89, v62
    v_xor_b32 v63, s89, v63
    v_xor_b32 v64, s89, v64
    v_xor_b32 v65, s89, v65
    v_xor_b32 v66, s89, v66
    v_xor_b32 v67, s89, v67
    v_xor_b32 v68, s89, v68
    v_xor_b32 v69, s89, v69
    v_xor_b32 v70, s89, v70
    v_xor_b32 v71, s89, v71
    v_xor_b32 v72, s89, v72
    v_xor_b32 v73, s89, v73
    v_xor_b32 v74, s89, v74
    v_xor_b32 v75, s89, v75
    v_or_b32 v7, v52, v53
    v_or3_b32 v7, v7, v54, v55
    v_or3_b32 v7, v7, v56, v57
    v_or3_b32 v7, v7, v58, v59
    v_or3_b32 v7, v7, v60, v61
    v_or3_b32 v7, v7, v62, v63
    v_or3_b32 v7, v7, v64, v65
    v_or3_b32 v7, v7, v66, v67
    v_or3_b32 v7, v7, v68, v69
    v_or3_b32 v7, v7, v70, v71
    v_or3_b32 v7, v7, v72, v73
    v_or3_b32 v7, v7, v74, v75
    v_and_b32 v7, 4095, v7
    v_cmp_ne_u32 vcc, 0, v7
    s_nop 4
    s_cbranch_vccz L_ok_b
    s_sub_u32 s100, s100, 1
    s_cbranch_scc1 L_ok_b
    s_mov_b64 exec, vcc
    s_add_u32 s84, s63, 4096
    buffer_load_dwordx2 v[68:69], v79, s[64:67], s63 offen offset:0 sc1
    buffer_load_dwordx2 v[70:71], v79, s[64:67], s63 offen offset:2048 sc1
    buffer_load_dwordx2 v[72:73], v79, s[64:67], s84 offen offset:0 sc1
    buffer_load_dwordx2 v[74:75], v79, s[64:67], s84 offen offset:2048 sc1
    buffer_load_dwordx4 v[52:55], v1, s[64:67], s62 offen offset:0 sc1
    buffer_load_dwordx4 v[56:59], v1, s[64:67], s62 offen offset:1024 sc1
    buffer_load_dwordx4 v[60:63], v1, s[64:67], s62 offen offset:2048 sc1
    buffer_load_dwordx4 v[64:67], v1, s[64:67], s62 offen offset:3072 sc1
    s_waitcnt vmcnt(0)
    s_branch L_chk_b
L_ok_b:
    s_mov_b64 exec, -1
    v_max3_f32 v20, v68, v70, v72
    v_max_f32 v20, v20, v74
    v_mul_f32 v68, s93, v68
    v_mul_f32 v70, s93, v70
    v_mul_f32 v72, s93, v72
    v_mul_f32 v74, s93, v74
    v_max_f32_dpp v20, v20, v20 row_ror:8 row_mask:0xf bank_mask:0xf
    v_mov_b32 v22, v20
    s_nop 1
    v_permlane16_swap_b32 v20, v22
    v_max_f32 v20, v20, v22
    v_mov_b32 v22, v20
    s_nop 1
    v_permlane32_swap_b32 v20, v22
    v_max_f32 v20, v20, v22
    v_mul_f32 v20, s93, v20
    v_sub_f32 v68, v68, v20
    v_sub_f32 v70, v70, v20
    v_sub_f32 v72, v72, v20
    v_sub_f32 v74, v74, v20
    v_exp_f32 v68, v68
    v_exp_f32 v70, v70
    v_exp_f32 v72, v72
    v_exp_f32 v74, v74
    v_mul_f32 v52, v52, v68
    v_mul_f32 v53, v53, v68
    v_mul_f32 v54, v54, v68
    v_mul_f32 v55, v55, v68
    v_mul_f32 v21, v69, v68
    v_fmac_f32 v52, v56, v70
    v_fmac_f32 v53, v57, v70
    v_fmac_f32 v54, v58, v70
    v_fmac_f32 v55, v59, v70
    v_fmac_f32 v21, v71, v70
    v_fmac_f32 v52, v60, v72
    v_fmac_f32 v53, v61, v72
    v_fmac_f32 v54, v62, v72
    v_fmac_f32 v55, v63, v72
    v_fmac_f32 v21, v73, v72
    v_fmac_f32 v52, v64, v74
    v_fmac_f32 v53, v65, v74
    v_fmac_f32 v54, v66, v74
    v_fmac_f32 v55, v67, v74
    v_fmac_f32 v21, v75, v74
    v_mov_b32 v22, v21
    v_permlane32_swap_b32 v52, v53
    v_permlane32_swap_b32 v54, v55
    v_permlane32_swap_b32 v21, v22
    v_add_f32 v52, v52, v53
    v_add_f32 v21, v21, v22
    v_add_f32 v54, v54, v55
    v_mov_b32 v22, v21
    s_mov_b32 s6, 0x00ff00ff
    s_mov_b32 s7, 0x00ff00ff
    v_permlane16_swap_b32 v52, v54
    v_permlane16_swap_b32 v21, v22
    v_add_f32 v52, v52, v54
    v_add_f32 v21, v21, v22
    s_nop 1
    v_add_f32_dpp v21, v21, v21 row_ror:8 row_mask:0xf bank_mask:0xf
    v_add_f32_dpp v52, v52, v52 row_ror:8 row_mask:0xf bank_mask:0xf
    v_rcp_f32 v21, v21
    s_nop 0
    v_mul_f32 v52, v52, v21
    v_cvt_pk_bf16_f32 v52, v52, v52
    s_mov_b64 exec, s[6:7]
    ds_write_b16 v80, v52 offset:4608
    s_mov_b64 exec, 1
    ds_add_u32 v3, v4 offset:20
    s_mov_b64 exec, -1
    s_mov_b64 exec, 1
    ds_add_rtn_u32 v9, v3, v4 offset:32
    s_mov_b64 exec, -1
    v_and_b32 v8, 16, v0
    v_cmp_ne_u32 vcc, 0, v8
    s_add_u32 s84, s94, 131072
    s_waitcnt lgkmcnt(0)
L_aw_ob:
    ds_read_b32 v7, v3 offset:20
    ds_read_b128 v[32:35], v82 offset:4608
    s_waitcnt lgkmcnt(0)
    v_readfirstlane_b32 s83, v7
    s_nop 0
    s_cmp_lt_u32 s83, 2
    s_cbranch_scc1 L_aw_ob
    v_mfma_f32_16x16x32_bf16 v[192:195], v[32:35], a[192:195], 0
    v_mfma_f32_16x16x32_bf16 v[208:211], v[32:35], a[208:211], 0
    v_mfma_f32_16x16x32_bf16 v[196:199], v[32:35], a[196:199], 0
    v_mfma_f32_16x16x32_bf16 v[212:215], v[32:35], a[212:215], 0
    v_mfma_f32_16x16x32_bf16 v[200:203], v[32:35], a[200:203], 0
    v_mfma_f32_16x16x32_bf16 v[216:219], v[32:35], a[216:219], 0
    v_mfma_f32_16x16x32_bf16 v[204:207], v[32:35], a[204:207], 0
    v_mfma_f32_16x16x32_bf16 v[220:223], v[32:35], a[220:223], 0
    v_readfirstlane_b32 s83, v9
    s_lshr_b32 s34, s82, 4
    s_lshl_b32 s34, s34, 2
    s_add_u32 s34, s34, s81
    s_lshl_b32 s34, s34, 12
    s_add_u32 s34, s34, 425984
    s_mov_b32 s35, 1
    s_cmp_lg_u32 s83, 3
    s_cbranch_scc1 L_nofireob
    s_atomic_add s35, s[64:65], s34
    s_add_u32 s34, s34, 256
    s_atomic_add s35, s[64:65], s34
    s_add_u32 s34, s34, 256
    s_atomic_add s35, s[64:65], s34
    s_add_u32 s34, s34, 256
    s_atomic_add s35, s[64:65], s34
    s_add_u32 s34, s34, 256
    s_atomic_add s35, s[64:65], s34
    s_add_u32 s34, s34, 256
    s_atomic_add s35, s[64:65], s34
    s_add_u32 s34, s34, 256
    s_atomic_add s35, s[64:65], s34
    s_add_u32 s34, s34, 256
    s_atomic_add s35, s[64:65], s34
L_nofireob:
    v_mfma_f32_16x16x32_bf16 v[224:227], v[32:35], a[224:227], 0
    v_mfma_f32_16x16x32_bf16 v[240:243], v[32:35], a[240:243], 0
    v_mfma_f32_16x16x32_bf16 v[228:231], v[32:35], a[228:231], 0
    v_mfma_f32_16x16x32_bf16 v[244:247], v[32:35], a[244:247], 0
    v_mfma_f32_16x16x32_bf16 v[232:235], v[32:35], a[232:235], 0
    v_mfma_f32_16x16x32_bf16 v[248:251], v[32:35], a[248:251], 0
    v_mfma_f32_16x16x32_bf16 v[236:239], v[32:35], a[236:239], 0
    v_mfma_f32_16x16x32_bf16 v[252:255], v[32:35], a[252:255], 0
    v_cndmask_b32 v36, v192, v208, vcc
    v_cndmask_b32 v37, v196, v212, vcc
    v_cndmask_b32 v38, v200, v216, vcc
    v_cndmask_b32 v39, v204, v220, vcc
    v_bfi_b32 v36, s95, v5, v36
    v_bfi_b32 v37, s95, v5, v37
    v_bfi_b32 v38, s95, v5, v38
    v_bfi_b32 v39, s95, v5, v39
    buffer_store_dwordx4 v[36:39], v81, s[64:67], s94 offen sc1
    v_cndmask_b32 v40, v224, v240, vcc
    v_cndmask_b32 v41, v228, v244, vcc
    v_cndmask_b32 v42, v232, v248, vcc
    v_cndmask_b32 v43, v236, v252, vcc
    v_bfi_b32 v40, s95, v5, v40
    v_bfi_b32 v41, s95, v5, v41
    v_bfi_b32 v42, s95, v5, v42
    v_bfi_b32 v43, s95, v5, v43
    buffer_store_dwordx4 v[40:43], v81, s[64:67], s84 offen sc1
L_fin:
L_end:
    s_endpgm
.section .rodata,"a"
.p2align 6
.amdhsa_kernel gated_mix__sliding_block_cached__gqa_block_cached__decode_kernel
  .amdhsa_next_free_vgpr 512
  .amdhsa_next_free_sgpr 102
  .amdhsa_accum_offset 256
  .amdhsa_group_segment_fixed_size 0
  .amdhsa_kernarg_size 112
  .amdhsa_user_sgpr_count 2
  .amdhsa_user_sgpr_kernarg_segment_ptr 1
  .amdhsa_system_sgpr_workgroup_id_x 1
  .amdhsa_float_denorm_mode_32 3
.end_amdhsa_kernel
```
